```python
import torch

def _softmax(x, axis=-1):
    return torch.softmax(x, dim=axis)

def _gelu(x):
    return torch.nn.functional.gelu(x, approximate='tanh')

def _silu(x):
    return torch.nn.functional.silu(x)

def _sigmoid(x):
    return torch.sigmoid(x)

def _layernorm(x, axis=-1, eps=1e-05):
    m = x.mean(dim=axis, keepdim=True)
    v = x.var(dim=axis, keepdim=True, unbiased=False)
    return (x - m) / torch.sqrt(v + eps)

def _scatter_add(tgt, idx, src, axis=0):
    return tgt.clone().index_add_(axis, idx, src)

def _segment_sum(src, seg, n):
    out = torch.zeros((n,) + src.shape[1:], dtype=src.dtype)
    return out.index_add_(0, seg, src)

def _pad(x, pw):
    flat = tuple((v for pair in reversed(pw) for v in pair))
    return torch.nn.functional.pad(x, flat)
kernel_name = 'adaLN_cond__linear_kernel_hedgehog__dense_activation_relu__prompt'

def setup_inputs():

    _w = lambda a: (lambda t: t.to(torch.bfloat16) if t.is_floating_point() else t)(torch.as_tensor(a))

    def _A_setup():
        B, S, D, H = (1, 2048, 512, 32)
        Dh = D // H
        return {'x': _w((lambda *s: torch.randn(*s, dtype=torch.bfloat16) * 0.05)(B, S, D)), 'wqkv': _w((lambda *s: torch.randn(*s, dtype=torch.bfloat16) * 0.4)(D, 3 * D)), 'w_phi': _w((lambda *s: torch.randn(*s, dtype=torch.bfloat16) * 0.4)(H, Dh, Dh) * Dh ** (-0.5)), 'wo': _w((lambda *s: torch.randn(*s, dtype=torch.bfloat16) * 0.05)(D, D))}
    _A_in = _A_setup()

    def _B_setup():
        B, S, D, Dff = (1, 2048, 512, 1376)
        return {'x': _w((lambda *s: torch.randn(*s, dtype=torch.bfloat16) * 0.05)(B, S, D)), 'w1': _w((lambda *s: torch.randn(*s, dtype=torch.bfloat16) * 0.05)(D, Dff)), 'w2': _w((lambda *s: torch.randn(*s, dtype=torch.bfloat16) * 0.05)(Dff, D))}
    _B_in = _B_setup()
    return {'A_x': _A_in['x'], 'A_wqkv': _A_in['wqkv'], 'A_w_phi': _A_in['w_phi'], 'A_wo': _A_in['wo'], 'B_x': _B_in['x'], 'B_w1': _B_in['w1'], 'B_w2': _B_in['w2'], 'c': _w((lambda *s: torch.randn(*s, dtype=torch.bfloat16) * 0.1)(1, 512) * 8.0), 'w_mod': _w((lambda *s: torch.randn(*s, dtype=torch.bfloat16) * 0.1)(512, 6 * 512) * 512 ** (-0.5) * 8.0)}

def reference(A_x, A_wqkv, A_w_phi, A_wo, B_x, B_w1, B_w2, c, w_mod):

    def _A_ref(x, wqkv, w_phi, wo):
        B, S, D = x.shape
        H = 32
        Dh = D // H
        qkv = (lambda x, *d: x.permute(*d))((x @ wqkv).reshape(B, S, 3, H, Dh), 2, 0, 3, 1, 4)
        q, k, v = (qkv[0], qkv[1], qkv[2])
        pq = torch.einsum('bhsd,hdf->bhsf', q, w_phi)
        pk = torch.einsum('bhsd,hdf->bhsf', k, w_phi)
        phi_q = torch.concatenate([_softmax(pq, axis=-1), _softmax(-pq, axis=-1)], axis=-1)
        phi_k = torch.concatenate([_softmax(pk, axis=-1), _softmax(-pk, axis=-1)], axis=-1)
        kv = torch.einsum('bhsf,bhsd->bhfd', phi_k, v)
        z = torch.einsum('bhsf->bhf', phi_k)
        num = torch.einsum('bhqf,bhfd->bhqd', phi_q, kv)
        den = torch.einsum('bhqf,bhf->bhq', phi_q, z)[..., None] + 1e-06
        o = num / den
        return (lambda x, *d: x.permute(*d))(o, 0, 2, 1, 3).reshape(B, S, D) @ wo

    def _B_ref(x, w1, w2):
        h = torch.einsum('bsd,df->bsf', x, w1)
        zero = torch.zeros_like(h)
        h = torch.maximum(h, zero)
        return torch.einsum('bsf,fd->bsd', h, w2)
    x = A_x
    mod = (_silu(c) @ w_mod).reshape(c.shape[0], 6, 1, -1)
    sa, ca, ga, sb, cb, gb = (mod[:, 0].clone(), mod[:, 1].clone(), mod[:, 2].clone(), mod[:, 3].clone(), mod[:, 4].clone(), mod[:, 5].clone())
    h = _layernorm(x, axis=-1) * (1 + ca) + sa
    x = x + ga * _A_ref(h, A_wqkv, A_w_phi, A_wo)
    h = _layernorm(x, axis=-1) * (1 + cb) + sb
    x = x + gb * _B_ref(h, B_w1, B_w2)
    return x
```

```asm
; @launch grid=(256,1,1) block=(512,1,1) lds=163840
.amdgcn_target "amdgcn-amd-amdhsa--gfx950"
.text
.globl adaLN_cond__linear_kernel_hedgehog__dense_activation_relu__prompt_kernel
.p2align 8
.type adaLN_cond__linear_kernel_hedgehog__dense_activation_relu__prompt_kernel,@function
adaLN_cond__linear_kernel_hedgehog__dense_activation_relu__prompt_kernel:
    s_lshr_b32 s7, s2, 3
    s_cmp_ge_u32 s7, 32
    s_cbranch_scc1 L_end
    s_load_dwordx2 s[68:69], s[0:1], 64
    s_load_dwordx2 s[64:65], s[0:1], 56
    s_load_dwordx2 s[40:41], s[0:1], 0
    s_load_dwordx2 s[44:45], s[0:1], 8
    v_readfirstlane_b32 s5, v0
    s_and_b32 s8, s2, 7
    s_add_u32 s91, s7, 8
    s_and_b32 s97, s91, 16
    s_and_b32 s10, s2, 4
    s_or_b32 s97, s97, s10
    s_and_b32 s11, s91, 15
    s_bitcmp1_b32 s5, 8
    s_cbranch_scc1 L_c1
    s_setprio 3
    s_cmp_lg_u32 s97, 0
    s_cbranch_scc1 L_h2
    s_lshl_b32 s10, s8, 7
    v_lshrrev_b32 v8, 3, v0
    v_lshl_add_u32 v8, v8, 2, s10
    s_lshl_b32 s11, s11, 7
    s_addk_i32 s11, 3072
    v_and_b32 v9, 7, v0
    v_lshl_add_u32 v9, v9, 4, s11
    v_mul_u32_u24 v11, 6144, v8
    v_add_u32 v11, v11, v9
    v_lshlrev_b32 v10, 1, v8
    v_add_u32 v9, 12288, v11
    s_waitcnt lgkmcnt(0)
    global_load_dwordx2 v[144:145], v10, s[64:65]
    global_load_dwordx4 v[128:131], v11, s[68:69] offset:-3072
    global_load_dwordx4 v[132:135], v11, s[68:69] offset:3072
    global_load_dwordx4 v[136:139], v9, s[68:69] offset:-3072
    global_load_dwordx4 v[140:143], v9, s[68:69] offset:3072
    s_branch L_h2
L_c1:
    s_lshl_b32 s10, s8, 5
    s_add_u32 s87, s10, s7
    s_lshl2_add_u32 s10, s87, -1
    s_lshl_b32 s10, s10, 11
    v_lshl_add_u32 v19, v0, 4, s10
    s_cmpk_lg_u32 s5, 448
    s_cbranch_scc1 L_1
    s_getpc_b64 s[12:13]
L_pc:
    s_lshl_b32 s10, s7, 7
    v_and_b32 v16, 63, v0
    v_lshl_add_u32 v16, v16, 12, s10
    v_min_u32 v16, L_end-L_pc, v16
    global_load_dword v30, v16, s[12:13]
L_1:
    s_waitcnt lgkmcnt(0)
    global_load_dwordx4 v[8:11], v19, s[40:41] offset:-2048
    global_load_dwordx4 v[12:15], v19, s[40:41] offset:2048
    s_lshl_b32 s11, s11, 5
    v_bfe_u32 v17, v0, 3, 5
    v_add_u32 v17, s11, v17
    v_mul_u32_u24 v17, 3072, v17
    v_and_b32 v18, 7, v0
    v_lshl_add_u32 v32, v18, 7, v17
    s_load_dwordx2 s[76:77], s[0:1], 88
    s_load_dwordx2 s[48:49], s[0:1], 16
    s_load_dwordx2 s[52:53], s[0:1], 24
    s_load_dwordx2 s[56:57], s[0:1], 40
    s_load_dwordx2 s[60:61], s[0:1], 48
    s_load_dwordx2 s[72:73], s[0:1], 72
    v_and_b32 v1, 63, v0
    s_lshr_b32 s5, s5, 6
    s_xor_b32 s5, s5, 4
    s_lshr_b32 s3, s7, 4
    s_lshl1_add_u32 s3, s8, s3
    s_and_b32 s4, s7, 15
    s_and_b32 s9, s5, 3
    v_lshlrev_b32 v2, 4, v1
    v_mov_b32 v4, 0
    v_lshrrev_b32 v3, 5, v1
    v_mov_b32 v0, s9
    v_mov_b32 v5, 1
    s_waitcnt lgkmcnt(0)
    s_load_dword s6, s[76:77], 0
    s_barrier
    s_bitcmp0_b32 s91, 4
    s_cbranch_scc1 L_2
    s_bitcmp0_b32 s2, 2
    s_cbranch_scc1 L_2
    global_load_dword v33, v32, s[44:45] offset:1024
    v_add_u32 v32, 1024, v32
L_2:
    s_mov_b32 s80, 0x3f803f80
    s_mov_b32 s81, 0x3fb8aa3b
    s_mov_b32 s96, 0x01010101
    s_mov_b32 s84, 0
    s_mov_b32 s70, 3145728
    s_mov_b32 s71, 0x20000
    s_mov_b32 s66, 1024
    s_mov_b32 s67, 0x20000
    s_mov_b32 s42, 2097152
    s_mov_b32 s43, 0x20000
    s_mov_b32 s46, 1572864
    s_mov_b32 s47, 0x20000
    s_mov_b32 s50, 16384
    s_mov_b32 s51, 0x20000
    s_mov_b32 s78, 16777216
    s_mov_b32 s79, 0x20000
    s_mov_b32 s54, 524288
    s_mov_b32 s55, 0x20000
    s_mov_b32 s58, 1409024
    s_mov_b32 s59, 0x20000
    s_mov_b32 s62, 1409024
    s_mov_b32 s63, 0x20000
    s_mov_b32 s74, 2097152
    s_mov_b32 s75, 0x20000
    v_lshrrev_b32 v16, 3, v1
    v_lshrrev_b32 v17, 4, v1
    v_xor_b32 v18, v17, v1
    v_and_b32 v18, 7, v18
    v_lshlrev_b32 v18, 4, v18
    v_lshl_add_u32 v34, v16, 10, v18
    v_xor_b32 v35, 64, v34
    s_lshl2_add_u32 s85, s3, s5
    s_lshl_b32 s85, s85, 15
    s_mul_i32 s86, s5, 20480
    v_lshlrev_b32 v26, 3, v17
    v_lshl_add_u32 v26, v3, 5, v26
    v_lshl_add_u32 v26, v3, 4, v26
    s_lshl3_add_u32 s11, s87, s5
    s_lshl_b32 s11, s11, 4
    s_add_u32 s11, s11, 65536
    s_waitcnt lgkmcnt(0)
    s_bitcmp0_b32 s91, 4
    s_cbranch_scc1 L_3
    s_bitcmp1_b32 s2, 2
    s_cbranch_scc1 L_3
    global_load_dword v33, v32, s[44:45] offset:1024
    v_add_u32 v32, 1024, v32
L_3:
    s_mul_i32 s10, s6, 0x9E3779B1
    s_add_u32 s10, s10, 0x7F4A7C15
    s_and_b32 s10, s10, 0xffffff00
    s_add_u32 s6, s6, 1
    s_and_b32 s6, s6, 0xff
    s_or_b32 s6, s6, s10
    s_bitcmp1_b32 s91, 4
    s_waitcnt vmcnt(1)
    s_cbranch_scc1 L_4
    s_waitcnt vmcnt(0)
L_4:
    v_dot2_f32_bf16 v20, v8, s80, 0
    v_dot2_f32_bf16 v22, v8, v8, 0
    v_dot2_f32_bf16 v20, v9, s80, v20
    v_dot2_f32_bf16 v22, v9, v9, v22
    v_dot2_f32_bf16 v20, v10, s80, v20
    v_dot2_f32_bf16 v22, v10, v10, v22
    v_dot2_f32_bf16 v20, v11, s80, v20
    v_dot2_f32_bf16 v22, v11, v11, v22
    v_dot2_f32_bf16 v21, v12, s80, 0
    v_dot2_f32_bf16 v23, v12, v12, 0
    v_dot2_f32_bf16 v21, v13, s80, v21
    v_dot2_f32_bf16 v23, v13, v13, v23
    v_dot2_f32_bf16 v21, v14, s80, v21
    v_dot2_f32_bf16 v23, v14, v14, v23
    v_dot2_f32_bf16 v21, v15, s80, v21
    v_dot2_f32_bf16 v23, v15, v15, v23
    s_nop 1
    v_permlane32_swap_b32 v20, v21
    v_permlane32_swap_b32 v22, v23
    v_mov_b32 v25, s6
    v_add_f32 v20, v20, v21
    v_add_f32 v22, v22, v23
    s_nop 1
    v_permlane16_swap_b32 v20, v22
    v_add_f32 v24, v20, v22
    s_nop 1
    v_add_f32_dpp v24, v24, v24 row_ror:8 row_mask:0xf bank_mask:0xf
    s_nop 1
    v_add_f32_dpp v24, v24, v24 row_ror:4 row_mask:0xf bank_mask:0xf
    s_nop 1
    v_add_f32_dpp v24, v24, v24 row_ror:2 row_mask:0xf bank_mask:0xf
    s_nop 1
    v_add_f32_dpp v24, v24, v24 row_ror:1 row_mask:0xf bank_mask:0xf
    s_mov_b32 exec_lo, 0x10001
    s_mov_b32 exec_hi, 0x10001
    buffer_store_dwordx2 v[24:25], v26, s[76:79], s11 offen sc1
    s_getreg_b32 s10, hwreg(HW_REG_XCC_ID, 0, 4)
    s_lshl_b32 s11, s87, 7
    v_mov_b32 v29, s6
    v_mov_b32 v28, s10
    s_add_u32 s11, s11, 32768
    s_cmp_eq_u32 s5, 0
    s_cselect_b64 exec, 1, 0
    buffer_store_dwordx2 v[28:29], off, s[76:79], s11 sc1
    s_mov_b64 exec, -1
    s_branch L_c3
L_h2:
    s_load_dwordx2 s[76:77], s[0:1], 88
    s_load_dwordx2 s[48:49], s[0:1], 16
    s_load_dwordx2 s[52:53], s[0:1], 24
    s_load_dwordx2 s[56:57], s[0:1], 40
    s_load_dwordx2 s[60:61], s[0:1], 48
    s_load_dwordx2 s[72:73], s[0:1], 72
    v_and_b32 v1, 63, v0
    s_lshr_b32 s5, s5, 6
    s_xor_b32 s5, s5, 4
    s_lshr_b32 s3, s7, 4
    s_lshl1_add_u32 s3, s8, s3
    s_and_b32 s4, s7, 15
    s_and_b32 s9, s5, 3
    v_lshlrev_b32 v2, 4, v1
    v_mov_b32 v4, 0
    v_lshrrev_b32 v3, 5, v1
    v_mov_b32 v0, s9
    v_mov_b32 v5, 1
    v_lshlrev_b32 v8, 2, v1
    ds_write_b32 v8, v4 offset:6912
    v_and_b32 v8, 0x7c, v8
    ds_write_b32 v8, v4
    s_waitcnt lgkmcnt(0)
    s_load_dword s6, s[76:77], 0
    s_barrier
    s_mov_b32 s80, 0x3f803f80
    s_mov_b32 s81, 0x3fb8aa3b
    s_mov_b32 s96, 0x01010101
    s_mov_b32 s84, 0
    s_mov_b32 s70, 3145728
    s_mov_b32 s71, 0x20000
    s_mov_b32 s66, 1024
    s_mov_b32 s67, 0x20000
    s_mov_b32 s42, 2097152
    s_mov_b32 s43, 0x20000
    s_mov_b32 s46, 1572864
    s_mov_b32 s47, 0x20000
    s_mov_b32 s50, 16384
    s_mov_b32 s51, 0x20000
    s_mov_b32 s78, 16777216
    s_mov_b32 s79, 0x20000
    s_mov_b32 s54, 524288
    s_mov_b32 s55, 0x20000
    s_mov_b32 s58, 1409024
    s_mov_b32 s59, 0x20000
    s_mov_b32 s62, 1409024
    s_mov_b32 s63, 0x20000
    s_mov_b32 s74, 2097152
    s_mov_b32 s75, 0x20000
    v_lshrrev_b32 v8, 2, v1
    v_and_b32 v9, 0x30, v2
    s_movk_i32 s11, 3072
    v_mad_u32_u24 v13, v8, s11, v9
    v_and_b32 v9, 0x30, v1
    v_xor_b32 v12, v13, v9
    s_and_b32 s87, s4, 7
    s_lshl_b32 s85, s9, 1
    s_xor_b32 s85, s85, s87
    s_xor_b32 s99, s85, 1
    s_mul_i32 s85, s85, 196608
    s_mul_i32 s99, s99, 196608
    s_lshl_b32 s11, s4, 6
    s_add_u32 s85, s85, s11
    s_add_u32 s99, s99, s11
    s_lshl_b32 s87, s87, 8
    s_lshl_b32 s86, s9, 13
    s_lshl_b32 s10, s4, 10
    s_mov_b32 m0, 13312
    s_nop 0
    buffer_load_dwordx4 v2, s[48:51], s10 offen lds
    v_bfe_u32 v8, v1, 2, 2
    v_lshl_add_u32 v8, v3, 3, v8
    v_bfe_u32 v9, v1, 4, 1
    v_bfe_u32 v10, v1, 1, 1
    v_lshl_add_u32 v9, v9, 1, v10
    v_lshlrev_b32 v9, 3, v9
    v_and_b32 v10, 1, v1
    v_lshl_add_u32 v11, v8, 5, v9
    v_lshl_add_u32 v11, v10, 9, v11
    v_mov_b32 v52, v11
    v_lshl_add_u32 v17, v8, 6, v9
    v_lshl_add_u32 v17, v10, 5, v17
    s_add_u32 s10, s86, 131072
    v_add_u32 v17, s10, v17
    v_bfe_u32 v8, v1, 3, 1
    v_bfe_u32 v9, v1, 2, 1
    v_cmp_eq_u32 s[94:95], 0, v9
    v_lshl_add_u32 v8, v9, 1, v8
    v_and_b32 v9, 3, v1
    v_lshl_add_u32 v10, v8, 2, v9
    v_and_b32 v9, 16, v1
    v_cmp_eq_u32 s[12:13], 0, v9
    v_add_u32 v9, v9, v10
    v_mov_b32 v23, v9
    v_xor_b32 v8, v8, v3
    v_lshlrev_b32 v8, 4, v8
    v_lshl_add_u32 v8, v9, 6, v8
    s_add_u32 s10, s86, 98304
    v_xor_b32 v9, 32, v8
    v_add_u32 v14, s10, v8
    v_add_u32 v15, s10, v9
    v_add_u32 v16, s10, v2
    v_lshlrev_b32 v8, 3, v3
    v_sub_u32 v8, v10, v8
    v_mov_b32 v9, 0xffff
    v_mov_b32 v10, 0xffff0000
    v_cmp_eq_u32 vcc, 0, v8
    s_nop 1
    v_cndmask_b32 v11, 0, v9, vcc
    v_cmp_eq_u32 vcc, 1, v8
    s_nop 1
    v_cndmask_b32 v11, v11, v10, vcc
    v_cndmask_b32 v40, 0, v11, s[12:13]
    v_cndmask_b32 v44, v11, 0, s[12:13]
    v_cmp_eq_u32 vcc, 2, v8
    s_nop 1
    v_cndmask_b32 v11, 0, v9, vcc
    v_cmp_eq_u32 vcc, 3, v8
    s_nop 1
    v_cndmask_b32 v11, v11, v10, vcc
    v_cndmask_b32 v41, 0, v11, s[12:13]
    v_cndmask_b32 v45, v11, 0, s[12:13]
    v_cmp_eq_u32 vcc, 4, v8
    s_nop 1
    v_cndmask_b32 v11, 0, v9, vcc
    v_cmp_eq_u32 vcc, 5, v8
    s_nop 1
    v_cndmask_b32 v11, v11, v10, vcc
    v_cndmask_b32 v42, 0, v11, s[12:13]
    v_cndmask_b32 v46, v11, 0, s[12:13]
    v_cmp_eq_u32 vcc, 6, v8
    s_nop 1
    v_cndmask_b32 v11, 0, v9, vcc
    v_cmp_eq_u32 vcc, 7, v8
    s_nop 1
    v_cndmask_b32 v11, v11, v10, vcc
    v_cndmask_b32 v43, 0, v11, s[12:13]
    v_cndmask_b32 v47, v11, 0, s[12:13]
    s_lshl_b32 s10, s9, 9
    s_add_u32 s11, s10, 11264
    v_bfe_u32 v8, v1, 1, 1
    v_lshlrev_b32 v8, 8, v8
    v_lshl_add_u32 v8, v3, 4, v8
    v_add_u32 v8, s11, v8
    v_lshrrev_b32 v9, 4, v1
    v_xor_b32 v9, v9, v1
    v_and_b32 v9, 1, v9
    v_cmp_eq_u32 vcc, 0, v9
    v_mov_b32 v9, 6912
    s_nop 0
    v_cndmask_b32 v18, v9, v8, vcc
    v_lshlrev_b32 v8, 3, v1
    v_add_u32 v21, s11, v8
    v_and_b32 v8, 0x1f0, v2
    v_xor_b32 v9, 1, v3
    v_lshl_add_u32 v20, v9, 13, v8
    v_cvt_f32_u32 v24, v9
    v_add_u32 v20, s10, v20
    v_xor_b32 v20, s87, v20
    s_add_u32 s11, s10, 14336
    v_add_u32 v22, s11, v8
    v_lshl_add_u32 v23, v23, 2, s11
    v_lshl_add_u32 v25, v3, 5, s11
    s_lshr_b32 s10, s9, 1
    s_lshl_b32 s10, s10, 9
    s_and_b32 s11, s9, 1
    s_lshl_b32 s11, s11, 3
    s_add_u32 s10, s10, s11
    v_add_u32 v19, s10, v2
    s_mov_b32 s89, 0x0c0c0400
    s_mov_b32 s90, 0x04000c0c
    s_cmp_lg_u32 s97, 0
    s_cbranch_scc1 L_89
    s_and_b32 s11, s91, 15
    s_lshr_b32 s88, s11, 3
    s_and_b32 s12, s8, 3
    s_lshl2_add_u32 s88, s88, s12
    s_and_b32 s12, s11, 7
    s_lshl3_add_u32 s88, s88, s12
    s_lshl_b32 s88, s88, 8
    s_add_u32 s88, s88, 655360
    s_mov_b32 s12, 0x05040100
    s_mov_b32 s13, 0x07060302
    v_and_b32 v8, 7, v1
    v_lshrrev_b32 v9, 4, v1
    v_lshl_add_u32 v8, v8, 3, v9
    s_lshl_b32 s10, s9, 8
    s_add_u32 s10, s10, 7168
    v_lshlrev_b32 v8, 2, v8
    v_add_u32 v8, s10, v8
    v_and_b32 v9, 0xf0, v2
    s_waitcnt vmcnt(5)
    v_lshlrev_b32 v146, 16, v144
    v_and_b32 v147, 0xffff0000, v144
    v_lshlrev_b32 v148, 16, v145
    v_and_b32 v149, 0xffff0000, v145
    v_mul_f32 v150, s81, v146
    v_mul_f32 v151, s81, v147
    v_mul_f32 v152, s81, v148
    v_mul_f32 v153, s81, v149
    v_exp_f32_e64 v150, -v150
    v_exp_f32_e64 v151, -v151
    v_exp_f32_e64 v152, -v152
    v_exp_f32_e64 v153, -v153
    v_add_f32 v150, 1.0, v150
    v_add_f32 v151, 1.0, v151
    v_add_f32 v152, 1.0, v152
    v_add_f32 v153, 1.0, v153
    v_rcp_f32 v150, v150
    v_rcp_f32 v151, v151
    v_rcp_f32 v152, v152
    v_rcp_f32 v153, v153
    v_mul_f32 v146, v146, v150
    v_mul_f32 v147, v147, v151
    v_mul_f32 v148, v148, v152
    v_mul_f32 v149, v149, v153
    v_cvt_pk_bf16_f32 v178, v146, v147
    v_cvt_pk_bf16_f32 v179, v148, v149
    s_waitcnt vmcnt(1)
    v_perm_b32 v146, v132, v128, s12
    v_perm_b32 v147, v132, v128, s13
    v_perm_b32 v148, v133, v129, s12
    v_perm_b32 v149, v133, v129, s13
    v_perm_b32 v150, v134, v130, s12
    v_perm_b32 v151, v134, v130, s13
    v_perm_b32 v152, v135, v131, s12
    v_perm_b32 v153, v135, v131, s13
    v_dot2_f32_bf16 v170, v146, v178, 0
    v_dot2_f32_bf16 v171, v147, v178, 0
    v_dot2_f32_bf16 v172, v148, v178, 0
    v_dot2_f32_bf16 v173, v149, v178, 0
    v_dot2_f32_bf16 v174, v150, v178, 0
    v_dot2_f32_bf16 v175, v151, v178, 0
    v_dot2_f32_bf16 v176, v152, v178, 0
    v_dot2_f32_bf16 v177, v153, v178, 0
    v_perm_b32 v154, v140, v136, s12
    v_perm_b32 v155, v140, v136, s13
    v_perm_b32 v156, v141, v137, s12
    v_perm_b32 v157, v141, v137, s13
    v_perm_b32 v158, v142, v138, s12
    v_perm_b32 v159, v142, v138, s13
    v_perm_b32 v160, v143, v139, s12
    v_perm_b32 v161, v143, v139, s13
    v_dot2_f32_bf16 v170, v154, v179, v170
    v_dot2_f32_bf16 v171, v155, v179, v171
    v_dot2_f32_bf16 v172, v156, v179, v172
    v_dot2_f32_bf16 v173, v157, v179, v173
    v_dot2_f32_bf16 v174, v158, v179, v174
    v_dot2_f32_bf16 v175, v159, v179, v175
    v_dot2_f32_bf16 v176, v160, v179, v176
    v_dot2_f32_bf16 v177, v161, v179, v177
    v_permlane16_swap_b32 v170, v171
    v_permlane16_swap_b32 v172, v173
    v_permlane16_swap_b32 v174, v175
    v_permlane16_swap_b32 v176, v177
    v_add_f32 v146, v170, v171
    v_add_f32 v147, v172, v173
    v_add_f32 v148, v174, v175
    v_add_f32 v149, v176, v177
    v_permlane32_swap_b32 v146, v147
    s_nop 0
    v_permlane32_swap_b32 v148, v149
    v_add_f32 v170, v146, v147
    v_add_f32 v171, v148, v149
    s_nop 0
    v_add_f32_dpp v170, v170, v170 row_ror:8 row_mask:0xf bank_mask:0xf
    v_add_f32_dpp v171, v171, v171 row_ror:8 row_mask:0xf bank_mask:0xf
    ds_write2_b32 v8, v170, v171 offset1:4
    s_mov_b64 exec, 1
    ds_add_rtn_u32 v11, v4, v5 offset:0
    s_mov_b64 exec, -1
    ds_read_b128 v[128:131], v9 offset:7168
    ds_read_b128 v[132:135], v9 offset:7424
    ds_read_b128 v[136:139], v9 offset:7680
    ds_read_b128 v[140:143], v9 offset:7936
    s_mov_b32 s12, 0x07060500
    s_mov_b32 s13, 0x07060501
    s_mov_b32 s14, 0x07060502
    s_mov_b32 s15, 0x07060503
    s_waitcnt vmcnt(0) lgkmcnt(0)
    v_readfirstlane_b32 s11, v11
    s_mul_i32 s10, s6, 0x9E3779B1
    s_add_u32 s10, s10, 0x7F4A7C15
    s_and_b32 s10, s10, 0xffffff00
    s_add_u32 s6, s6, 1
    s_and_b32 s6, s6, 0xff
    s_or_b32 s6, s6, s10
    v_mov_b32 v10, s6
    v_add_f32 v128, v128, v132
    v_add_f32 v136, v136, v140
    v_add_f32 v129, v129, v133
    v_add_f32 v137, v137, v141
    v_add_f32 v130, v130, v134
    v_add_f32 v138, v138, v142
    v_add_f32 v131, v131, v135
    v_add_f32 v139, v139, v143
    s_cmp_lg_u32 s11, 3
    s_cbranch_scc1 L_88
    v_add_f32 v128, v128, v136
    v_perm_b32 v128, v128, v10, s12
    v_add_f32 v129, v129, v137
    v_perm_b32 v129, v129, v10, s13
    v_add_f32 v130, v130, v138
    v_perm_b32 v130, v130, v10, s14
    v_add_f32 v131, v131, v139
    v_perm_b32 v131, v131, v10, s15
    s_mov_b64 exec, 0xffff
    buffer_store_dwordx4 v[128:131], v9, s[76:79], s88 offen sc1
    ds_write_b32 v4, v5 offset:112
    s_mov_b64 exec, -1
    s_nop 1
L_88:
L_89:
    s_cmp_eq_u32 s97, 0
    s_waitcnt lgkmcnt(0)
    s_cbranch_scc1 L_91
    s_mul_i32 s10, s6, 0x9E3779B1
    s_add_u32 s10, s10, 0x7F4A7C15
    s_and_b32 s10, s10, 0xffffff00
    s_add_u32 s6, s6, 1
    s_and_b32 s6, s6, 0xff
    s_or_b32 s6, s6, s10
    s_waitcnt vmcnt(0)
L_91:
    ds_read_b64_tr_b16 v[48:49], v52 offset:13312
    ds_read_b64_tr_b16 v[50:51], v52 offset:13440
    s_waitcnt lgkmcnt(1)
    v_cndmask_b32 v32, 0, v48, s[94:95]
    v_cndmask_b32 v36, v48, 0, s[94:95]
    v_cndmask_b32 v33, 0, v49, s[94:95]
    v_cndmask_b32 v37, v49, 0, s[94:95]
    s_waitcnt lgkmcnt(0)
    v_cndmask_b32 v34, 0, v50, s[94:95]
    v_cndmask_b32 v38, v50, 0, s[94:95]
    v_cndmask_b32 v35, 0, v51, s[94:95]
    v_cndmask_b32 v39, v51, 0, s[94:95]
    s_setprio 3
    s_bitcmp1_b32 s91, 4
    s_cbranch_scc1 L_92
    ds_read_u8 v6, v0 offset:124
    s_waitcnt lgkmcnt(0)
    v_cmp_eq_u32 vcc, 1, v6
    s_cbranch_vccnz F_94
F_93:
    ds_read_u8 v6, v0 offset:124
    s_add_u32 s84, s84, 1
    s_waitcnt lgkmcnt(0)
    v_cmp_ne_u32 vcc, 1, v6
    s_cmp_gt_u32 s84, 200000
    s_cbranch_scc1 F_94
    s_cbranch_vccnz F_93
F_94:
L_92:
    v_lshlrev_b32 v28, 7, v1
    s_add_u32 m0, s86, 97280
    s_add_u32 s11, s85, 0
    buffer_load_dwordx4 v12, s[44:47], s11 offen offset:1024 lds
    s_add_u32 m0, s86, 98304
    s_add_u32 s11, s85, 49152
    buffer_load_dwordx4 v12, s[44:47], s11 offen offset:1024 lds
    s_add_u32 m0, s86, 99328
    s_add_u32 s11, s85, 98304
    buffer_load_dwordx4 v12, s[44:47], s11 offen offset:1024 lds
    s_add_u32 m0, s86, 100352
    s_add_u32 s11, s85, 147456
    buffer_load_dwordx4 v12, s[44:47], s11 offen offset:1024 lds
    s_cmp_lt_u32 s8, 6
    s_cbranch_scc1 L_95
    s_mov_b32 s14, 655360
    s_mov_b32 s15, 659456
    buffer_load_dwordx4 v[128:131], v20, s[76:79], s14 offen offset:0 sc1
    buffer_load_dwordx4 v[132:135], v20, s[76:79], s14 offen offset:2048 sc1
    buffer_load_dwordx4 v[136:139], v20, s[76:79], s15 offen offset:0 sc1
    buffer_load_dwordx4 v[140:143], v20, s[76:79], s15 offen offset:2048 sc1
L_95:
    s_add_u32 m0, s86, 101376
    s_add_u32 s11, s99, 0
    buffer_load_dwordx4 v12, s[44:47], s11 offen offset:1024 lds
    s_add_u32 m0, s86, 102400
    s_add_u32 s11, s99, 49152
    buffer_load_dwordx4 v12, s[44:47], s11 offen offset:1024 lds
    s_add_u32 m0, s86, 103424
    s_add_u32 s11, s99, 98304
    buffer_load_dwordx4 v12, s[44:47], s11 offen offset:1024 lds
    s_add_u32 m0, s86, 104448
    s_add_u32 s11, s99, 147456
    buffer_load_dwordx4 v12, s[44:47], s11 offen offset:1024 lds
    s_barrier
    s_mov_b32 s98, 0
    s_cmp_lt_u32 s8, 6
    s_cbranch_scc1 L_96
    s_waitcnt vmcnt(4)
    v_perm_b32 v8, v129, v128, s89
    v_perm_b32 v9, v131, v130, s90
    v_bitop3_b32 v10, v8, v9, s6 bitop3:0x56
    v_perm_b32 v8, v133, v132, s89
    v_perm_b32 v9, v135, v134, s90
    v_bitop3_b32 v8, v8, v9, s6 bitop3:0x56
    v_or_b32 v10, v10, v8
    v_perm_b32 v8, v137, v136, s89
    v_perm_b32 v9, v139, v138, s90
    v_bitop3_b32 v8, v8, v9, s6 bitop3:0x56
    v_or_b32 v10, v10, v8
    v_perm_b32 v8, v141, v140, s89
    v_perm_b32 v9, v143, v142, s90
    v_bitop3_b32 v8, v8, v9, s6 bitop3:0x56
    v_or_b32 v10, v10, v8
    v_cmp_ne_u32 vcc, 0, v10
    s_cbranch_vccnz L_96
    v_and_b32 v128, 0xffffff00, v128
    v_and_b32 v129, 0xffffff00, v129
    v_and_b32 v130, 0xffffff00, v130
    v_and_b32 v131, 0xffffff00, v131
    v_and_b32 v132, 0xffffff00, v132
    v_and_b32 v133, 0xffffff00, v133
    v_and_b32 v134, 0xffffff00, v134
    v_and_b32 v135, 0xffffff00, v135
    v_and_b32 v136, 0xffffff00, v136
    v_and_b32 v137, 0xffffff00, v137
    v_and_b32 v138, 0xffffff00, v138
    v_and_b32 v139, 0xffffff00, v139
    v_and_b32 v140, 0xffffff00, v140
    v_and_b32 v141, 0xffffff00, v141
    v_and_b32 v142, 0xffffff00, v142
    v_and_b32 v143, 0xffffff00, v143
    v_pk_add_f32 v[128:129], v[128:129], v[132:133]
    v_pk_add_f32 v[130:131], v[130:131], v[134:135]
    v_pk_add_f32 v[136:137], v[136:137], v[140:141]
    v_pk_add_f32 v[138:139], v[138:139], v[142:143]
    v_pk_add_f32 v[128:129], v[128:129], v[136:137]
    v_pk_add_f32 v[130:131], v[130:131], v[138:139]
    v_cvt_pk_bf16_f32 v132, v128, v129
    v_cvt_pk_bf16_f32 v133, v130, v131
    v_lshlrev_b32 v128, 16, v132
    v_and_b32 v129, 0xffff0000, v132
    v_lshlrev_b32 v130, 16, v133
    v_and_b32 v131, 0xffff0000, v133
    v_add_f32 v128, v24, v128
    v_add_f32 v129, v24, v129
    v_add_f32 v130, v24, v130
    v_add_f32 v131, v24, v131
    v_cvt_pk_bf16_f32 v132, v128, v129
    v_cvt_pk_bf16_f32 v133, v130, v131
    v_lshlrev_b32 v128, 16, v132
    v_and_b32 v129, 0xffff0000, v132
    v_lshlrev_b32 v130, 16, v133
    v_and_b32 v131, 0xffff0000, v133
    s_mov_b32 exec_hi, 0
    ds_write_b128 v22, v[128:131]
    s_mov_b32 exec_hi, -1
    ds_read_b128 v[64:67], v25 offset:0
    ds_read_b128 v[68:71], v25 offset:16
    ds_read_b128 v[72:75], v25 offset:64
    ds_read_b128 v[76:79], v25 offset:80
    ds_read_b128 v[80:83], v25 offset:128
    ds_read_b128 v[84:87], v25 offset:144
    ds_read_b128 v[88:91], v25 offset:192
    ds_read_b128 v[92:95], v25 offset:208
    ds_write_b64 v21, v[132:133]
    s_mov_b32 s98, 1
L_96:
    s_waitcnt vmcnt(0)
    s_cmp_eq_u32 s98, 1
    s_cbranch_scc1 L_97
    s_mov_b32 s14, 655360
    s_mov_b32 s15, 659456
    buffer_load_dwordx4 v[128:131], v20, s[76:79], s14 offen offset:0 sc1
    buffer_load_dwordx4 v[132:135], v20, s[76:79], s14 offen offset:2048 sc1
    buffer_load_dwordx4 v[136:139], v20, s[76:79], s15 offen offset:0 sc1
    buffer_load_dwordx4 v[140:143], v20, s[76:79], s15 offen offset:2048 sc1
L_97:
    ds_read_b128 v[96:99], v14 offset:0
    ds_read_b128 v[100:103], v15 offset:0
    ds_read_b128 v[104:107], v14 offset:2048
    ds_read_b128 v[108:111], v15 offset:2048
    ds_read_b128 v[112:115], v14 offset:4096
    ds_read_b128 v[116:119], v15 offset:4096
    ds_read_b128 v[120:123], v14 offset:6144
    ds_read_b128 v[124:127], v15 offset:6144
    s_waitcnt lgkmcnt(7)
    v_mfma_f32_32x32x16_bf16 v[192:207], v[96:99], v[32:35], 0
    s_waitcnt lgkmcnt(6)
    v_mfma_f32_32x32x16_bf16 v[192:207], v[100:103], v[36:39], v[192:207]
    s_waitcnt lgkmcnt(5)
    v_mfma_f32_32x32x16_bf16 v[208:223], v[104:107], v[32:35], 0
    s_waitcnt lgkmcnt(4)
    v_mfma_f32_32x32x16_bf16 v[208:223], v[108:111], v[36:39], v[208:223]
    s_waitcnt lgkmcnt(3)
    v_mfma_f32_32x32x16_bf16 v[224:239], v[112:115], v[32:35], 0
    s_waitcnt lgkmcnt(2)
    v_mfma_f32_32x32x16_bf16 v[224:239], v[116:119], v[36:39], v[224:239]
    s_waitcnt lgkmcnt(1)
    v_mfma_f32_32x32x16_bf16 v[240:255], v[120:123], v[32:35], 0
    s_waitcnt lgkmcnt(0)
    v_mfma_f32_32x32x16_bf16 v[240:255], v[124:127], v[36:39], v[240:255]
    s_cmp_eq_u32 s98, 1
    s_cbranch_scc1 L_98
M_99:
    s_add_u32 s84, s84, 8
    s_waitcnt vmcnt(0)
    s_mov_b64 exec, -1
    v_perm_b32 v8, v129, v128, s89
    v_perm_b32 v9, v131, v130, s90
    v_bitop3_b32 v10, v8, v9, s6 bitop3:0x56
    v_perm_b32 v8, v133, v132, s89
    v_perm_b32 v9, v135, v134, s90
    v_bitop3_b32 v8, v8, v9, s6 bitop3:0x56
    v_or_b32 v10, v10, v8
    v_perm_b32 v8, v137, v136, s89
    v_perm_b32 v9, v139, v138, s90
    v_bitop3_b32 v8, v8, v9, s6 bitop3:0x56
    v_or_b32 v10, v10, v8
    v_perm_b32 v8, v141, v140, s89
    v_perm_b32 v9, v143, v142, s90
    v_bitop3_b32 v8, v8, v9, s6 bitop3:0x56
    v_or_b32 v10, v10, v8
    v_cmp_ne_u32 vcc, 0, v10
    s_cmp_gt_u32 s84, 200000
    s_cbranch_scc1 M_100
    s_cbranch_vccz M_100
    s_mov_b64 exec, vcc
    s_mov_b32 s14, 655360
    s_mov_b32 s15, 659456
    buffer_load_dwordx4 v[128:131], v20, s[76:79], s14 offen offset:0 sc1
    buffer_load_dwordx4 v[132:135], v20, s[76:79], s14 offen offset:2048 sc1
    buffer_load_dwordx4 v[136:139], v20, s[76:79], s15 offen offset:0 sc1
    buffer_load_dwordx4 v[140:143], v20, s[76:79], s15 offen offset:2048 sc1
    s_branch M_99
M_100:
    v_and_b32 v128, 0xffffff00, v128
    v_and_b32 v129, 0xffffff00, v129
    v_and_b32 v130, 0xffffff00, v130
    v_and_b32 v131, 0xffffff00, v131
    v_and_b32 v132, 0xffffff00, v132
    v_and_b32 v133, 0xffffff00, v133
    v_and_b32 v134, 0xffffff00, v134
    v_and_b32 v135, 0xffffff00, v135
    v_and_b32 v136, 0xffffff00, v136
    v_and_b32 v137, 0xffffff00, v137
    v_and_b32 v138, 0xffffff00, v138
    v_and_b32 v139, 0xffffff00, v139
    v_and_b32 v140, 0xffffff00, v140
    v_and_b32 v141, 0xffffff00, v141
    v_and_b32 v142, 0xffffff00, v142
    v_and_b32 v143, 0xffffff00, v143
    v_pk_add_f32 v[128:129], v[128:129], v[132:133]
    v_pk_add_f32 v[130:131], v[130:131], v[134:135]
    v_pk_add_f32 v[136:137], v[136:137], v[140:141]
    v_pk_add_f32 v[138:139], v[138:139], v[142:143]
    v_pk_add_f32 v[128:129], v[128:129], v[136:137]
    v_pk_add_f32 v[130:131], v[130:131], v[138:139]
    v_cvt_pk_bf16_f32 v132, v128, v129
    v_cvt_pk_bf16_f32 v133, v130, v131
    v_lshlrev_b32 v128, 16, v132
    v_and_b32 v129, 0xffff0000, v132
    v_lshlrev_b32 v130, 16, v133
    v_and_b32 v131, 0xffff0000, v133
    v_add_f32 v128, v24, v128
    v_add_f32 v129, v24, v129
    v_add_f32 v130, v24, v130
    v_add_f32 v131, v24, v131
    v_cvt_pk_bf16_f32 v132, v128, v129
    v_cvt_pk_bf16_f32 v133, v130, v131
    v_lshlrev_b32 v128, 16, v132
    v_and_b32 v129, 0xffff0000, v132
    v_lshlrev_b32 v130, 16, v133
    v_and_b32 v131, 0xffff0000, v133
    s_mov_b32 exec_hi, 0
    ds_write_b128 v22, v[128:131]
    s_mov_b32 exec_hi, -1
    ds_read_b128 v[64:67], v25 offset:0
    ds_read_b128 v[68:71], v25 offset:16
    ds_read_b128 v[72:75], v25 offset:64
    ds_read_b128 v[76:79], v25 offset:80
    ds_read_b128 v[80:83], v25 offset:128
    ds_read_b128 v[84:87], v25 offset:144
    ds_read_b128 v[88:91], v25 offset:192
    ds_read_b128 v[92:95], v25 offset:208
    ds_write_b64 v21, v[132:133]
L_98:
    s_waitcnt lgkmcnt(8)
    v_pk_mul_f32 v[64:65], v[64:65], v[192:193]
    v_pk_mul_f32 v[66:67], v[66:67], v[194:195]
    s_waitcnt lgkmcnt(7)
    v_pk_mul_f32 v[68:69], v[68:69], v[196:197]
    v_pk_mul_f32 v[70:71], v[70:71], v[198:199]
    v_cvt_pk_bf16_f32 v48, v64, v65
    v_cvt_pk_bf16_f32 v49, v66, v67
    v_cvt_pk_bf16_f32 v50, v68, v69
    v_cvt_pk_bf16_f32 v51, v70, v71
    ds_write_b128 v16, v[48:51] offset:0
    s_waitcnt lgkmcnt(7)
    v_pk_mul_f32 v[72:73], v[72:73], v[200:201]
    v_pk_mul_f32 v[74:75], v[74:75], v[202:203]
    s_waitcnt lgkmcnt(6)
    v_pk_mul_f32 v[76:77], v[76:77], v[204:205]
    v_pk_mul_f32 v[78:79], v[78:79], v[206:207]
    v_cvt_pk_bf16_f32 v52, v72, v73
    v_cvt_pk_bf16_f32 v53, v74, v75
    v_cvt_pk_bf16_f32 v54, v76, v77
    v_cvt_pk_bf16_f32 v55, v78, v79
    ds_write_b128 v16, v[52:55] offset:1024
    ds_read_b128 v[64:67], v25 offset:256
    ds_read_b128 v[68:71], v25 offset:272
    ds_read_b128 v[72:75], v25 offset:320
    ds_read_b128 v[76:79], v25 offset:336
    s_waitcnt lgkmcnt(10)
    v_pk_mul_f32 v[80:81], v[80:81], v[208:209]
    v_pk_mul_f32 v[82:83], v[82:83], v[210:211]
    s_waitcnt lgkmcnt(9)
    v_pk_mul_f32 v[84:85], v[84:85], v[212:213]
    v_pk_mul_f32 v[86:87], v[86:87], v[214:215]
    v_cvt_pk_bf16_f32 v56, v80, v81
    v_cvt_pk_bf16_f32 v57, v82, v83
    v_cvt_pk_bf16_f32 v58, v84, v85
    v_cvt_pk_bf16_f32 v59, v86, v87
    ds_write_b128 v16, v[56:59] offset:2048
    s_waitcnt lgkmcnt(9)
    v_pk_mul_f32 v[88:89], v[88:89], v[216:217]
    v_pk_mul_f32 v[90:91], v[90:91], v[218:219]
    s_waitcnt lgkmcnt(8)
    v_pk_mul_f32 v[92:93], v[92:93], v[220:221]
    v_pk_mul_f32 v[94:95], v[94:95], v[222:223]
    v_cvt_pk_bf16_f32 v60, v88, v89
    v_cvt_pk_bf16_f32 v61, v90, v91
    v_cvt_pk_bf16_f32 v62, v92, v93
    v_cvt_pk_bf16_f32 v63, v94, v95
    ds_write_b128 v16, v[60:63] offset:3072
    ds_read_b128 v[80:83], v25 offset:384
    ds_read_b128 v[84:87], v25 offset:400
    ds_read_b128 v[88:91], v25 offset:448
    ds_read_b128 v[92:95], v25 offset:464
    s_waitcnt lgkmcnt(9)
    v_pk_mul_f32 v[64:65], v[64:65], v[224:225]
    v_pk_mul_f32 v[66:67], v[66:67], v[226:227]
    s_waitcnt lgkmcnt(8)
    v_pk_mul_f32 v[68:69], v[68:69], v[228:229]
    v_pk_mul_f32 v[70:71], v[70:71], v[230:231]
    v_cvt_pk_bf16_f32 v48, v64, v65
    v_cvt_pk_bf16_f32 v49, v66, v67
    v_cvt_pk_bf16_f32 v50, v68, v69
    v_cvt_pk_bf16_f32 v51, v70, v71
    ds_write_b128 v16, v[48:51] offset:4096
    s_waitcnt lgkmcnt(8)
    v_pk_mul_f32 v[72:73], v[72:73], v[232:233]
    v_pk_mul_f32 v[74:75], v[74:75], v[234:235]
    s_waitcnt lgkmcnt(7)
    v_pk_mul_f32 v[76:77], v[76:77], v[236:237]
    v_pk_mul_f32 v[78:79], v[78:79], v[238:239]
    v_cvt_pk_bf16_f32 v52, v72, v73
    v_cvt_pk_bf16_f32 v53, v74, v75
    v_cvt_pk_bf16_f32 v54, v76, v77
    v_cvt_pk_bf16_f32 v55, v78, v79
    ds_write_b128 v16, v[52:55] offset:5120
    s_waitcnt lgkmcnt(5)
    v_pk_mul_f32 v[80:81], v[80:81], v[240:241]
    v_pk_mul_f32 v[82:83], v[82:83], v[242:243]
    s_waitcnt lgkmcnt(4)
    v_pk_mul_f32 v[84:85], v[84:85], v[244:245]
    v_pk_mul_f32 v[86:87], v[86:87], v[246:247]
    v_cvt_pk_bf16_f32 v56, v80, v81
    v_cvt_pk_bf16_f32 v57, v82, v83
    v_cvt_pk_bf16_f32 v58, v84, v85
    v_cvt_pk_bf16_f32 v59, v86, v87
    ds_write_b128 v16, v[56:59] offset:6144
    s_waitcnt lgkmcnt(4)
    v_pk_mul_f32 v[88:89], v[88:89], v[248:249]
    v_pk_mul_f32 v[90:91], v[90:91], v[250:251]
    s_waitcnt lgkmcnt(3)
    v_pk_mul_f32 v[92:93], v[92:93], v[252:253]
    v_pk_mul_f32 v[94:95], v[94:95], v[254:255]
    v_cvt_pk_bf16_f32 v60, v88, v89
    v_cvt_pk_bf16_f32 v61, v90, v91
    v_cvt_pk_bf16_f32 v62, v92, v93
    v_cvt_pk_bf16_f32 v63, v94, v95
    ds_write_b128 v16, v[60:63] offset:7168
    s_mov_b64 exec, 1
    ds_write_b8 v0, v5 offset:8
    s_mov_b64 exec, -1
    v_cvt_pk_bf16_f32 v96, v192, v193
    v_cvt_pk_bf16_f32 v97, v194, v195
    v_cvt_pk_bf16_f32 v98, v196, v197
    v_cvt_pk_bf16_f32 v99, v198, v199
    v_cvt_pk_bf16_f32 v100, v200, v201
    v_cvt_pk_bf16_f32 v101, v202, v203
    v_cvt_pk_bf16_f32 v102, v204, v205
    v_cvt_pk_bf16_f32 v103, v206, v207
    v_cvt_pk_bf16_f32 v104, v208, v209
    v_cvt_pk_bf16_f32 v105, v210, v211
    v_cvt_pk_bf16_f32 v106, v212, v213
    v_cvt_pk_bf16_f32 v107, v214, v215
    v_cvt_pk_bf16_f32 v108, v216, v217
    v_cvt_pk_bf16_f32 v109, v218, v219
    v_cvt_pk_bf16_f32 v110, v220, v221
    v_cvt_pk_bf16_f32 v111, v222, v223
    v_cvt_pk_bf16_f32 v112, v224, v225
    v_cvt_pk_bf16_f32 v113, v226, v227
    v_cvt_pk_bf16_f32 v114, v228, v229
    v_cvt_pk_bf16_f32 v115, v230, v231
    v_cvt_pk_bf16_f32 v116, v232, v233
    v_cvt_pk_bf16_f32 v117, v234, v235
    v_cvt_pk_bf16_f32 v118, v236, v237
    v_cvt_pk_bf16_f32 v119, v238, v239
    v_cvt_pk_bf16_f32 v120, v240, v241
    v_cvt_pk_bf16_f32 v121, v242, v243
    v_cvt_pk_bf16_f32 v122, v244, v245
    v_cvt_pk_bf16_f32 v123, v246, v247
    v_cvt_pk_bf16_f32 v124, v248, v249
    v_cvt_pk_bf16_f32 v125, v250, v251
    v_cvt_pk_bf16_f32 v126, v252, v253
    v_cvt_pk_bf16_f32 v127, v254, v255
    ds_read_b128 v[160:163], v18 offset:0
    ds_read_b128 v[164:167], v18 offset:32
    ds_read_b128 v[168:171], v18 offset:64
    ds_read_b128 v[172:175], v18 offset:96
    ds_read_b128 v[176:179], v18 offset:128
    ds_read_b128 v[180:183], v18 offset:160
    ds_read_b128 v[184:187], v18 offset:192
    ds_read_b128 v[188:191], v18 offset:224
    s_waitcnt lgkmcnt(7)
    v_mfma_f32_16x16x32_bf16 v[224:227], v[160:163], v[96:99], 0
    s_waitcnt lgkmcnt(6)
    v_mfma_f32_16x16x32_bf16 v[228:231], v[164:167], v[100:103], 0
    s_waitcnt lgkmcnt(5)
    v_mfma_f32_16x16x32_bf16 v[224:227], v[168:171], v[104:107], v[224:227]
    s_waitcnt lgkmcnt(4)
    v_mfma_f32_16x16x32_bf16 v[228:231], v[172:175], v[108:111], v[228:231]
    s_waitcnt lgkmcnt(3)
    v_mfma_f32_16x16x32_bf16 v[224:227], v[176:179], v[112:115], v[224:227]
    s_waitcnt lgkmcnt(2)
    v_mfma_f32_16x16x32_bf16 v[228:231], v[180:183], v[116:119], v[228:231]
    s_waitcnt lgkmcnt(1)
    v_mfma_f32_16x16x32_bf16 v[224:227], v[184:187], v[120:123], v[224:227]
    s_waitcnt lgkmcnt(0)
    v_mfma_f32_16x16x32_bf16 v[228:231], v[188:191], v[124:127], v[228:231]
    s_nop 7
    v_add_f32 v224, v224, v228
    v_add_f32 v225, v225, v229
    v_add_f32 v226, v226, v230
    v_add_f32 v227, v227, v231
    v_cvt_pk_bf16_f32 v8, v224, v226
    v_and_b32 v9, 0xffff0000, v8
    v_sub_f32 v9, v226, v9
    v_cvt_pk_bf16_f32 v9, v226, v9
    v_cvt_pk_bf16_f32 v10, v225, v227
    v_and_b32 v11, 0xffff0000, v10
    v_sub_f32 v11, v227, v11
    v_cvt_pk_bf16_f32 v11, v227, v11
    s_mov_b64 exec, 0xffff
    ds_write_b64 v19, v[8:9] offset:8192
    ds_write_b64 v19, v[10:11] offset:8448
    s_mov_b64 exec, 1
    ds_write_b8 v0, v5 offset:12
    s_mov_b64 exec, -1
    ds_read_u8 v6, v0 offset:4
    s_waitcnt lgkmcnt(0)
    v_cmp_eq_u32 vcc, 1, v6
    s_cbranch_vccnz F_102
F_101:
    ds_read_u8 v6, v0 offset:4
    s_add_u32 s84, s84, 1
    s_waitcnt lgkmcnt(0)
    v_cmp_ne_u32 vcc, 1, v6
    s_cmp_gt_u32 s84, 200000
    s_cbranch_scc1 F_102
    s_cbranch_vccnz F_101
F_102:
    s_add_u32 m0, s86, 129024
    s_add_u32 s11, s85, 0
    buffer_load_dwordx4 v13, s[44:47], s11 offen offset:2048 lds
    s_add_u32 m0, s86, 130048
    s_add_u32 s11, s85, 49152
    buffer_load_dwordx4 v13, s[44:47], s11 offen offset:2048 lds
    s_add_u32 m0, s86, 131072
    s_add_u32 s11, s85, 98304
    buffer_load_dwordx4 v13, s[44:47], s11 offen offset:2048 lds
    s_add_u32 m0, s86, 132096
    s_add_u32 s11, s85, 147456
    buffer_load_dwordx4 v13, s[44:47], s11 offen offset:2048 lds
    s_add_u32 m0, s86, 133120
    s_add_u32 s11, s99, 0
    buffer_load_dwordx4 v13, s[44:47], s11 offen offset:2048 lds
    s_add_u32 m0, s86, 134144
    s_add_u32 s11, s99, 49152
    buffer_load_dwordx4 v13, s[44:47], s11 offen offset:2048 lds
    s_add_u32 m0, s86, 135168
    s_add_u32 s11, s99, 98304
    buffer_load_dwordx4 v13, s[44:47], s11 offen offset:2048 lds
    s_add_u32 m0, s86, 136192
    s_add_u32 s11, s99, 147456
    buffer_load_dwordx4 v13, s[44:47], s11 offen offset:2048 lds
    ds_read2_b32 v[8:9], v23 offset1:32
    ds_read2_b32 v[10:11], v23 offset0:64 offset1:96
    s_waitcnt lgkmcnt(1)
    v_cvt_pk_bf16_f32 v8, v8, v8
    v_cvt_pk_bf16_f32 v9, v9, v9
    s_waitcnt lgkmcnt(0)
    v_cvt_pk_bf16_f32 v10, v10, v10
    v_cvt_pk_bf16_f32 v11, v11, v11
    v_and_b32 v128, v40, v8
    v_and_b32 v129, v41, v8
    v_and_b32 v130, v42, v8
    v_and_b32 v131, v43, v8
    v_and_b32 v132, v44, v8
    v_and_b32 v133, v45, v8
    v_and_b32 v134, v46, v8
    v_and_b32 v135, v47, v8
    v_and_b32 v136, v40, v9
    v_and_b32 v137, v41, v9
    v_and_b32 v138, v42, v9
    v_and_b32 v139, v43, v9
    v_and_b32 v140, v44, v9
    v_and_b32 v141, v45, v9
    v_and_b32 v142, v46, v9
    v_and_b32 v143, v47, v9
    v_and_b32 v144, v40, v10
    v_and_b32 v145, v41, v10
    v_and_b32 v146, v42, v10
    v_and_b32 v147, v43, v10
    v_and_b32 v148, v44, v10
    v_and_b32 v149, v45, v10
    v_and_b32 v150, v46, v10
    v_and_b32 v151, v47, v10
    v_and_b32 v152, v40, v11
    v_and_b32 v153, v41, v11
    v_and_b32 v154, v42, v11
    v_and_b32 v155, v43, v11
    v_and_b32 v156, v44, v11
    v_and_b32 v157, v45, v11
    v_and_b32 v158, v46, v11
    v_and_b32 v159, v47, v11
    s_waitcnt vmcnt(0)
    ds_read_b64_tr_b16 v[64:65], v17 offset:0
    ds_read_b64_tr_b16 v[66:67], v17 offset:256
    ds_read_b64_tr_b16 v[68:69], v17 offset:1024
    ds_read_b64_tr_b16 v[70:71], v17 offset:1280
    ds_read_b64_tr_b16 v[72:73], v17 offset:2048
    ds_read_b64_tr_b16 v[74:75], v17 offset:2304
    ds_read_b64_tr_b16 v[76:77], v17 offset:3072
    ds_read_b64_tr_b16 v[78:79], v17 offset:3328
    ds_read_b64_tr_b16 v[80:81], v17 offset:4096
    ds_read_b64_tr_b16 v[82:83], v17 offset:4352
    ds_read_b64_tr_b16 v[84:85], v17 offset:5120
    ds_read_b64_tr_b16 v[86:87], v17 offset:5376
    ds_read_b64_tr_b16 v[88:89], v17 offset:6144
    ds_read_b64_tr_b16 v[90:91], v17 offset:6400
    ds_read_b64_tr_b16 v[92:93], v17 offset:7168
    ds_read_b64_tr_b16 v[94:95], v17 offset:7424
    s_and_b32 s10, s91, 15
    s_lshl2_add_u32 s10, s10, s9
    s_lshl_b32 s10, s10, 3
    v_lshrrev_b32 v8, 3, v1
    v_add_u32 v8, s10, v8
    s_bitcmp1_b32 s91, 4
    s_cselect_b32 s10, 1, 3
    s_cselect_b64 s[12:13], s[52:53], s[44:45]
    v_mul_u32_u24 v8, s10, v8
    v_and_b32 v9, 0x380, v28
    v_lshl_add_u32 v8, v8, 10, v9
    global_load_dword v31, v8, s[12:13]
    s_bitcmp0_b32 s91, 4
    s_cbranch_scc1 L_103
    s_and_b32 s10, s8, 3
    s_lshl2_add_u32 s10, s10, s9
    s_lshl_b32 s14, s10, 6
    s_mul_i32 s10, s10, 196608
    s_and_b32 s11, s8, 4
    s_lshl2_add_u32 s11, s11, s91
    s_lshr_b32 s88, s11, 3
    s_and_b32 s12, s8, 3
    s_lshl2_add_u32 s88, s88, s12
    s_and_b32 s12, s11, 7
    s_lshl3_add_u32 s88, s88, s12
    s_lshl_b32 s88, s88, 8
    s_add_u32 s88, s88, 655360
    s_lshl_b32 s11, s11, 7
    s_add_u32 s10, s10, s11
    v_lshrrev_b32 v8, 3, v1
    v_and_b32 v9, 0x70, v2
    v_lshlrev_b32 v10, 3, v8
    s_movk_i32 s11, 24576
    v_mad_u32_u24 v11, v8, s11, v9
    s_add_u32 s11, s10, 6144
    s_add_u32 s12, s10, 12288
    s_add_u32 s13, s10, 18432
    buffer_load_dwordx2 v[26:27], v10, s[64:67], s14 offen
    buffer_load_dwordx4 v[96:99], v11, s[68:71], s10 offen
    buffer_load_dwordx4 v[100:103], v11, s[68:71], s11 offen
    buffer_load_dwordx4 v[104:107], v11, s[68:71], s12 offen
    buffer_load_dwordx4 v[108:111], v11, s[68:71], s13 offen
L_103:
    s_waitcnt lgkmcnt(14)
    v_mfma_f32_32x32x16_bf16 v[224:239], v[128:131], v[64:67], 0
    s_waitcnt lgkmcnt(12)
    v_mfma_f32_32x32x16_bf16 v[224:239], v[132:135], v[68:71], v[224:239]
    s_waitcnt lgkmcnt(10)
    v_mfma_f32_32x32x16_bf16 v[240:255], v[136:139], v[72:75], 0
    s_waitcnt lgkmcnt(8)
    v_mfma_f32_32x32x16_bf16 v[240:255], v[140:143], v[76:79], v[240:255]
    s_nop 7
    v_cvt_pk_bf16_f32 v48, v224, v225
    v_cvt_pk_bf16_f32 v49, v226, v227
    v_cvt_pk_bf16_f32 v50, v228, v229
    v_cvt_pk_bf16_f32 v51, v230, v231
    ds_write_b128 v16, v[48:51] offset:32768
    v_cvt_pk_bf16_f32 v52, v232, v233
    v_cvt_pk_bf16_f32 v53, v234, v235
    v_cvt_pk_bf16_f32 v54, v236, v237
    v_cvt_pk_bf16_f32 v55, v238, v239
    ds_write_b128 v16, v[52:55] offset:33792
    s_waitcnt lgkmcnt(8)
    v_mfma_f32_32x32x16_bf16 v[224:239], v[144:147], v[80:83], 0
    s_waitcnt lgkmcnt(6)
    v_mfma_f32_32x32x16_bf16 v[224:239], v[148:151], v[84:87], v[224:239]
    v_cvt_pk_bf16_f32 v56, v240, v241
    v_cvt_pk_bf16_f32 v57, v242, v243
    v_cvt_pk_bf16_f32 v58, v244, v245
    v_cvt_pk_bf16_f32 v59, v246, v247
    ds_write_b128 v16, v[56:59] offset:34816
    v_cvt_pk_bf16_f32 v60, v248, v249
    v_cvt_pk_bf16_f32 v61, v250, v251
    v_cvt_pk_bf16_f32 v62, v252, v253
    v_cvt_pk_bf16_f32 v63, v254, v255
    ds_write_b128 v16, v[60:63] offset:35840
    s_waitcnt lgkmcnt(6)
    v_mfma_f32_32x32x16_bf16 v[240:255], v[152:155], v[88:91], 0
    s_waitcnt lgkmcnt(4)
    v_mfma_f32_32x32x16_bf16 v[240:255], v[156:159], v[92:95], v[240:255]
    v_cvt_pk_bf16_f32 v48, v224, v225
    v_cvt_pk_bf16_f32 v49, v226, v227
    v_cvt_pk_bf16_f32 v50, v228, v229
    v_cvt_pk_bf16_f32 v51, v230, v231
    ds_write_b128 v16, v[48:51] offset:36864
    v_cvt_pk_bf16_f32 v52, v232, v233
    v_cvt_pk_bf16_f32 v53, v234, v235
    v_cvt_pk_bf16_f32 v54, v236, v237
    v_cvt_pk_bf16_f32 v55, v238, v239
    ds_write_b128 v16, v[52:55] offset:37888
    s_nop 1
    v_cvt_pk_bf16_f32 v56, v240, v241
    v_cvt_pk_bf16_f32 v57, v242, v243
    v_cvt_pk_bf16_f32 v58, v244, v245
    v_cvt_pk_bf16_f32 v59, v246, v247
    ds_write_b128 v16, v[56:59] offset:38912
    v_cvt_pk_bf16_f32 v60, v248, v249
    v_cvt_pk_bf16_f32 v61, v250, v251
    v_cvt_pk_bf16_f32 v62, v252, v253
    v_cvt_pk_bf16_f32 v63, v254, v255
    ds_write_b128 v16, v[60:63] offset:39936
    s_mov_b64 exec, 1
    ds_write_b8 v0, v5 offset:16
    s_mov_b64 exec, -1
    v_mfma_f32_16x16x32_bf16 v[224:227], v[160:163], v[64:67], 0
    v_mfma_f32_16x16x32_bf16 v[228:231], v[164:167], v[68:71], 0
    v_mfma_f32_16x16x32_bf16 v[224:227], v[168:171], v[72:75], v[224:227]
    v_mfma_f32_16x16x32_bf16 v[228:231], v[172:175], v[76:79], v[228:231]
    v_mfma_f32_16x16x32_bf16 v[224:227], v[176:179], v[80:83], v[224:227]
    v_mfma_f32_16x16x32_bf16 v[228:231], v[180:183], v[84:87], v[228:231]
    v_mfma_f32_16x16x32_bf16 v[224:227], v[184:187], v[88:91], v[224:227]
    v_mfma_f32_16x16x32_bf16 v[228:231], v[188:191], v[92:95], v[228:231]
    s_nop 7
    v_add_f32 v224, v224, v228
    v_add_f32 v225, v225, v229
    v_add_f32 v226, v226, v230
    v_add_f32 v227, v227, v231
    v_cvt_pk_bf16_f32 v8, v224, v226
    v_and_b32 v9, 0xffff0000, v8
    v_sub_f32 v9, v226, v9
    v_cvt_pk_bf16_f32 v9, v226, v9
    v_cvt_pk_bf16_f32 v10, v225, v227
    v_and_b32 v11, 0xffff0000, v10
    v_sub_f32 v11, v227, v11
    v_cvt_pk_bf16_f32 v11, v227, v11
    s_mov_b64 exec, 0xffff
    ds_write_b64 v19, v[8:9] offset:9216
    ds_write_b64 v19, v[10:11] offset:9472
    s_mov_b64 exec, 1
    ds_write_b8 v0, v5 offset:20
    s_mov_b64 exec, -1
    s_setprio 0
    v_xor_b32 v20, s87, v20
    s_mul_i32 s82, s9, 20480
    s_add_u32 m0, s82, 28672
    s_add_u32 s11, s85, 0
    buffer_load_dwordx4 v12, s[44:47], s11 offen offset:0 lds
    s_add_u32 m0, s82, 29696
    s_add_u32 s11, s85, 49152
    buffer_load_dwordx4 v12, s[44:47], s11 offen offset:0 lds
    s_add_u32 m0, s82, 30720
    s_add_u32 s11, s85, 98304
    buffer_load_dwordx4 v12, s[44:47], s11 offen offset:0 lds
    s_add_u32 m0, s82, 31744
    s_add_u32 s11, s85, 147456
    buffer_load_dwordx4 v12, s[44:47], s11 offen offset:0 lds
    s_add_u32 m0, s82, 32768
    s_add_u32 s11, s99, 0
    buffer_load_dwordx4 v12, s[44:47], s11 offen offset:0 lds
    s_add_u32 m0, s82, 33792
    s_add_u32 s11, s99, 49152
    buffer_load_dwordx4 v12, s[44:47], s11 offen offset:0 lds
    s_add_u32 m0, s82, 34816
    s_add_u32 s11, s99, 98304
    buffer_load_dwordx4 v12, s[44:47], s11 offen offset:0 lds
    s_add_u32 m0, s82, 35840
    s_add_u32 s11, s99, 147456
    buffer_load_dwordx4 v12, s[44:47], s11 offen offset:0 lds
    ds_read_b32 v6, v4 offset:28
    s_sub_u32 s10, s82, s86
    s_add_u32 s10, s10, 4294897664
    v_add_u32 v14, s10, v14
    v_add_u32 v15, s10, v15
    v_add_u32 v16, s10, v16
    v_lshrrev_b32 v8, 3, v1
    v_and_b32 v9, 0x70, v2
    v_lshlrev_b32 v10, 2, v1
    v_and_b32 v10, 64, v10
    v_xor_b32 v9, v9, v10
    v_lshl_add_u32 v12, v8, 10, v9
    s_and_b32 s10, s4, 7
    s_lshl_b32 s10, s10, 7
    v_add_u32 v12, s10, v12
    s_and_b32 s99, s3, 1
    s_lshl_b32 s99, s99, 1
    s_lshr_b32 s10, s4, 3
    s_add_u32 s99, s99, s10
    s_lshl_b32 s99, s99, 1
    s_waitcnt lgkmcnt(0)
    v_cmp_eq_u32 vcc, s96, v6
    s_cbranch_vccnz F_105
F_104:
    ds_read_b32 v6, v4 offset:28
    s_add_u32 s84, s84, 1
    s_waitcnt lgkmcnt(0)
    v_cmp_ne_u32 vcc, s96, v6
    s_cmp_gt_u32 s84, 200000
    s_cbranch_scc1 F_105
    s_cbranch_vccnz F_104
F_105:
    s_add_u32 s10, s99, 0
    s_and_b32 s10, s10, 7
    s_lshl_b32 s10, s10, 10
    s_add_u32 s10, s10, s86
    s_add_u32 m0, s10, 98304
    s_lshl_b32 s10, s10, 3
    s_add_u32 s10, s10, 0
    buffer_load_dwordx4 v12, s[52:55], s10 offen lds
    s_add_u32 s10, s99, 1
    s_and_b32 s10, s10, 7
    s_lshl_b32 s10, s10, 10
    s_add_u32 s10, s10, s86
    s_add_u32 m0, s10, 98304
    s_lshl_b32 s10, s10, 3
    s_add_u32 s10, s10, 0
    buffer_load_dwordx4 v12, s[52:55], s10 offen lds
    s_add_u32 s10, s99, 2
    s_and_b32 s10, s10, 7
    s_lshl_b32 s10, s10, 10
    s_add_u32 s10, s10, s86
    s_add_u32 m0, s10, 98304
    s_lshl_b32 s10, s10, 3
    s_add_u32 s10, s10, 0
    buffer_load_dwordx4 v12, s[52:55], s10 offen lds
    s_add_u32 s10, s99, 3
    s_and_b32 s10, s10, 7
    s_lshl_b32 s10, s10, 10
    s_add_u32 s10, s10, s86
    s_add_u32 m0, s10, 98304
    s_lshl_b32 s10, s10, 3
    s_add_u32 s10, s10, 0
    buffer_load_dwordx4 v12, s[52:55], s10 offen lds
    s_add_u32 s10, s99, 4
    s_and_b32 s10, s10, 7
    s_lshl_b32 s10, s10, 10
    s_add_u32 s10, s10, s86
    s_add_u32 m0, s10, 98304
    s_lshl_b32 s10, s10, 3
    s_add_u32 s10, s10, 0
    buffer_load_dwordx4 v12, s[52:55], s10 offen lds
    s_add_u32 s10, s99, 5
    s_and_b32 s10, s10, 7
    s_lshl_b32 s10, s10, 10
    s_add_u32 s10, s10, s86
    s_add_u32 m0, s10, 98304
    s_lshl_b32 s10, s10, 3
    s_add_u32 s10, s10, 0
    buffer_load_dwordx4 v12, s[52:55], s10 offen lds
    s_add_u32 s10, s99, 6
    s_and_b32 s10, s10, 7
    s_lshl_b32 s10, s10, 10
    s_add_u32 s10, s10, s86
    s_add_u32 m0, s10, 98304
    s_lshl_b32 s10, s10, 3
    s_add_u32 s10, s10, 0
    buffer_load_dwordx4 v12, s[52:55], s10 offen lds
    s_add_u32 s10, s99, 7
    s_and_b32 s10, s10, 7
    s_lshl_b32 s10, s10, 10
    s_add_u32 s10, s10, s86
    s_add_u32 m0, s10, 98304
    s_lshl_b32 s10, s10, 3
    s_add_u32 s10, s10, 0
    buffer_load_dwordx4 v12, s[52:55], s10 offen lds
    v_lshrrev_b32 v8, 4, v1
    v_min_u32 v9, 2, v8
    v_cmp_eq_u32 vcc, 1, v8
    s_nop 1
    v_cndmask_b32 v29, 0, 1.0, vcc
    v_cmp_eq_u32 vcc, 0, v8
    s_nop 1
    v_cndmask_b32 v8, v9, -1, vcc
    v_lshlrev_b32 v8, 13, v8
    v_and_b32 v10, 0xf0, v2
    s_and_b32 s10, s4, 7
    s_lshl_b32 s10, s10, 8
    s_add_u32 s10, s10, 24576
    v_add3_u32 v23, v8, v10, s10
    v_add_u32 v20, 24576, v20
    v_lshl_add_u32 v30, v9, 8, v10
    s_and_b32 s98, s91, 15
    s_lshl2_add_u32 s98, s98, s9
    s_mul_i32 s98, s98, 22016
    s_lshl_b32 s10, s3, 1
    s_lshr_b32 s12, s4, 3
    s_add_u32 s10, s10, s12
    s_lshl_b32 s10, s10, 1
    s_lshr_b32 s12, s9, 1
    s_add_u32 s10, s10, s12
    s_lshl_b32 s10, s10, 4
    s_and_b32 s12, s4, 7
    s_lshl_b32 s12, s12, 1
    s_add_u32 s10, s10, s12
    s_and_b32 s12, s9, 1
    s_add_u32 s10, s10, s12
    s_lshl_b32 s11, s10, 8
    s_add_u32 s95, s11, 786432
    s_lshl_b32 s10, s10, 11
    s_add_u32 s94, s10, 0
    s_and_b32 s12, s4, 7
    s_lshr_b32 s13, s4, 3
    s_mul_i32 s82, s13, 43
    s_mul_i32 s13, s12, 5
    s_add_u32 s82, s82, s13
    s_max_u32 s13, s12, 5
    s_sub_u32 s13, s13, 5
    s_add_u32 s82, s82, s13
    s_cmp_ge_u32 s12, 5
    s_cselect_b32 s83, 1, 0
    s_lshl_b32 s10, s3, 2
    s_add_u32 s10, s10, s9
    s_mul_i32 s10, s10, 88064
    s_mul_i32 s11, s4, 3456
    s_add_u32 s10, s10, s11
    s_add_u32 s83, s10, 6324224
    s_bitcmp1_b32 s91, 4
    s_movk_i32 s10, 44
    s_cselect_b32 s10, 0, s10
    s_cselect_b32 s11, 0, 64
    s_lshl_b32 s10, s10, 7
    s_add_u32 s10, s10, s98
    v_cmp_gt_u32 vcc, s11, v1
    s_mov_b64 exec, vcc
    buffer_load_dword v31, v28, s[56:59], s10 offen
    s_mov_b64 exec, -1
    s_bitcmp0_b32 s91, 4
    s_cbranch_scc1 L_107
    s_mov_b32 s12, 0x05040100
    s_mov_b32 s13, 0x07060302
    v_and_b32 v8, 7, v1
    v_lshrrev_b32 v9, 4, v1
    v_lshl_add_u32 v8, v8, 3, v9
    s_lshl_b32 s10, s9, 8
    s_add_u32 s10, s10, 7168
    v_lshlrev_b32 v8, 2, v8
    v_add_u32 v8, s10, v8
    v_and_b32 v9, 0xf0, v2
    s_waitcnt vmcnt(17)
    v_lshlrev_b32 v64, 16, v26
    v_and_b32 v65, 0xffff0000, v26
    v_lshlrev_b32 v66, 16, v27
    v_and_b32 v67, 0xffff0000, v27
    v_mul_f32 v68, s81, v64
    v_mul_f32 v69, s81, v65
    v_mul_f32 v70, s81, v66
    v_mul_f32 v71, s81, v67
    v_exp_f32_e64 v68, -v68
    v_exp_f32_e64 v69, -v69
    v_exp_f32_e64 v70, -v70
    v_exp_f32_e64 v71, -v71
    v_add_f32 v68, 1.0, v68
    v_add_f32 v69, 1.0, v69
    v_add_f32 v70, 1.0, v70
    v_add_f32 v71, 1.0, v71
    v_rcp_f32 v68, v68
    v_rcp_f32 v69, v69
    v_rcp_f32 v70, v70
    v_rcp_f32 v71, v71
    v_mul_f32 v64, v64, v68
    v_mul_f32 v65, v65, v69
    v_mul_f32 v66, v66, v70
    v_mul_f32 v67, v67, v71
    v_cvt_pk_bf16_f32 v92, v64, v65
    v_cvt_pk_bf16_f32 v93, v66, v67
    v_perm_b32 v64, v100, v96, s12
    v_perm_b32 v65, v100, v96, s13
    v_perm_b32 v66, v101, v97, s12
    v_perm_b32 v67, v101, v97, s13
    v_perm_b32 v68, v102, v98, s12
    v_perm_b32 v69, v102, v98, s13
    v_perm_b32 v70, v103, v99, s12
    v_perm_b32 v71, v103, v99, s13
    v_dot2_f32_bf16 v84, v64, v92, 0
    v_dot2_f32_bf16 v85, v65, v92, 0
    v_dot2_f32_bf16 v86, v66, v92, 0
    v_dot2_f32_bf16 v87, v67, v92, 0
    v_dot2_f32_bf16 v88, v68, v92, 0
    v_dot2_f32_bf16 v89, v69, v92, 0
    v_dot2_f32_bf16 v90, v70, v92, 0
    v_dot2_f32_bf16 v91, v71, v92, 0
    v_perm_b32 v72, v108, v104, s12
    v_perm_b32 v73, v108, v104, s13
    v_perm_b32 v74, v109, v105, s12
    v_perm_b32 v75, v109, v105, s13
    v_perm_b32 v76, v110, v106, s12
    v_perm_b32 v77, v110, v106, s13
    v_perm_b32 v78, v111, v107, s12
    v_perm_b32 v79, v111, v107, s13
    v_dot2_f32_bf16 v84, v72, v93, v84
    v_dot2_f32_bf16 v85, v73, v93, v85
    v_dot2_f32_bf16 v86, v74, v93, v86
    v_dot2_f32_bf16 v87, v75, v93, v87
    v_dot2_f32_bf16 v88, v76, v93, v88
    v_dot2_f32_bf16 v89, v77, v93, v89
    v_dot2_f32_bf16 v90, v78, v93, v90
    v_dot2_f32_bf16 v91, v79, v93, v91
    v_permlane16_swap_b32 v84, v85
    v_permlane16_swap_b32 v86, v87
    v_permlane16_swap_b32 v88, v89
    v_permlane16_swap_b32 v90, v91
    v_add_f32 v64, v84, v85
    v_add_f32 v65, v86, v87
    v_add_f32 v66, v88, v89
    v_add_f32 v67, v90, v91
    v_permlane32_swap_b32 v64, v65
    s_nop 0
    v_permlane32_swap_b32 v66, v67
    v_add_f32 v84, v64, v65
    v_add_f32 v85, v66, v67
    s_nop 0
    v_add_f32_dpp v84, v84, v84 row_ror:8 row_mask:0xf bank_mask:0xf
    v_add_f32_dpp v85, v85, v85 row_ror:8 row_mask:0xf bank_mask:0xf
    ds_write2_b32 v8, v84, v85 offset1:4
    s_mov_b64 exec, 1
    ds_add_rtn_u32 v11, v4, v5 offset:0
    s_mov_b64 exec, -1
    ds_read_b128 v[96:99], v9 offset:7168
    ds_read_b128 v[100:103], v9 offset:7424
    ds_read_b128 v[104:107], v9 offset:7680
    ds_read_b128 v[108:111], v9 offset:7936
    s_mov_b32 s12, 0x07060500
    s_mov_b32 s13, 0x07060501
    s_mov_b32 s14, 0x07060502
    s_mov_b32 s15, 0x07060503
    s_waitcnt lgkmcnt(0)
    v_readfirstlane_b32 s11, v11
    v_mov_b32 v10, s6
    v_add_f32 v96, v96, v100
    v_add_f32 v104, v104, v108
    v_add_f32 v97, v97, v101
    v_add_f32 v105, v105, v109
    v_add_f32 v98, v98, v102
    v_add_f32 v106, v106, v110
    v_add_f32 v99, v99, v103
    v_add_f32 v107, v107, v111
    s_cmp_lg_u32 s11, 3
    s_cbranch_scc1 L_107
    v_add_f32 v96, v96, v104
    v_perm_b32 v96, v96, v10, s12
    v_add_f32 v97, v97, v105
    v_perm_b32 v97, v97, v10, s13
    v_add_f32 v98, v98, v106
    v_perm_b32 v98, v98, v10, s14
    v_add_f32 v99, v99, v107
    v_perm_b32 v99, v99, v10, s15
    s_mov_b64 exec, 0xffff
    buffer_store_dwordx4 v[96:99], v9, s[76:79], s88 offen sc1
    s_mov_b64 exec, -1
    s_nop 1
L_107:
    s_waitcnt vmcnt(9)
    ds_read_b128 v[64:67], v25 offset:0
    ds_read_b128 v[68:71], v25 offset:16
    ds_read_b128 v[72:75], v25 offset:64
    ds_read_b128 v[76:79], v25 offset:80
    ds_read_b128 v[80:83], v25 offset:128
    ds_read_b128 v[84:87], v25 offset:144
    ds_read_b128 v[88:91], v25 offset:192
    ds_read_b128 v[92:95], v25 offset:208
    ds_read_b128 v[96:99], v14 offset:0
    ds_read_b128 v[100:103], v15 offset:0
    ds_read_b128 v[104:107], v14 offset:2048
    ds_read_b128 v[108:111], v15 offset:2048
    ds_read_b128 v[112:115], v14 offset:4096
    ds_read_b128 v[116:119], v15 offset:4096
    ds_read_b128 v[120:123], v14 offset:6144
    ds_read_b128 v[124:127], v15 offset:6144
    s_waitcnt lgkmcnt(7)
    v_mfma_f32_32x32x16_bf16 v[192:207], v[96:99], v[32:35], 0
    s_waitcnt lgkmcnt(6)
    v_mfma_f32_32x32x16_bf16 v[192:207], v[100:103], v[36:39], v[192:207]
    s_waitcnt lgkmcnt(5)
    v_mfma_f32_32x32x16_bf16 v[208:223], v[104:107], v[32:35], 0
    s_waitcnt lgkmcnt(4)
    v_mfma_f32_32x32x16_bf16 v[208:223], v[108:111], v[36:39], v[208:223]
    s_waitcnt lgkmcnt(3)
    v_mfma_f32_32x32x16_bf16 v[224:239], v[112:115], v[32:35], 0
    s_waitcnt lgkmcnt(2)
    v_mfma_f32_32x32x16_bf16 v[224:239], v[116:119], v[36:39], v[224:239]
    s_waitcnt lgkmcnt(1)
    v_mfma_f32_32x32x16_bf16 v[240:255], v[120:123], v[32:35], 0
    s_waitcnt lgkmcnt(0)
    v_mfma_f32_32x32x16_bf16 v[240:255], v[124:127], v[36:39], v[240:255]
    v_pk_mul_f32 v[64:65], v[64:65], v[192:193]
    v_pk_mul_f32 v[66:67], v[66:67], v[194:195]
    v_pk_mul_f32 v[68:69], v[68:69], v[196:197]
    v_pk_mul_f32 v[70:71], v[70:71], v[198:199]
    v_cvt_pk_bf16_f32 v48, v64, v65
    v_cvt_pk_bf16_f32 v49, v66, v67
    v_cvt_pk_bf16_f32 v50, v68, v69
    v_cvt_pk_bf16_f32 v51, v70, v71
    ds_write_b128 v16, v[48:51] offset:0
    v_pk_mul_f32 v[72:73], v[72:73], v[200:201]
    v_pk_mul_f32 v[74:75], v[74:75], v[202:203]
    v_pk_mul_f32 v[76:77], v[76:77], v[204:205]
    v_pk_mul_f32 v[78:79], v[78:79], v[206:207]
    v_cvt_pk_bf16_f32 v52, v72, v73
    v_cvt_pk_bf16_f32 v53, v74, v75
    v_cvt_pk_bf16_f32 v54, v76, v77
    v_cvt_pk_bf16_f32 v55, v78, v79
    ds_write_b128 v16, v[52:55] offset:1024
    ds_read_b128 v[64:67], v25 offset:256
    ds_read_b128 v[68:71], v25 offset:272
    ds_read_b128 v[72:75], v25 offset:320
    ds_read_b128 v[76:79], v25 offset:336
    v_pk_mul_f32 v[80:81], v[80:81], v[208:209]
    v_pk_mul_f32 v[82:83], v[82:83], v[210:211]
    v_pk_mul_f32 v[84:85], v[84:85], v[212:213]
    v_pk_mul_f32 v[86:87], v[86:87], v[214:215]
    v_cvt_pk_bf16_f32 v56, v80, v81
    v_cvt_pk_bf16_f32 v57, v82, v83
    v_cvt_pk_bf16_f32 v58, v84, v85
    v_cvt_pk_bf16_f32 v59, v86, v87
    ds_write_b128 v16, v[56:59] offset:2048
    v_pk_mul_f32 v[88:89], v[88:89], v[216:217]
    v_pk_mul_f32 v[90:91], v[90:91], v[218:219]
    v_pk_mul_f32 v[92:93], v[92:93], v[220:221]
    v_pk_mul_f32 v[94:95], v[94:95], v[222:223]
    v_cvt_pk_bf16_f32 v60, v88, v89
    v_cvt_pk_bf16_f32 v61, v90, v91
    v_cvt_pk_bf16_f32 v62, v92, v93
    v_cvt_pk_bf16_f32 v63, v94, v95
    ds_write_b128 v16, v[60:63] offset:3072
    ds_read_b128 v[80:83], v25 offset:384
    ds_read_b128 v[84:87], v25 offset:400
    ds_read_b128 v[88:91], v25 offset:448
    ds_read_b128 v[92:95], v25 offset:464
    s_bitcmp1_b32 s91, 4
    s_movk_i32 s10, 108
    s_cselect_b32 s10, 0, s10
    s_cselect_b32 s11, 0, 40
    s_lshl_b32 s10, s10, 7
    s_add_u32 s10, s10, s98
    v_cmp_gt_u32 vcc, s11, v1
    s_mov_b64 exec, vcc
    buffer_load_dword v31, v28, s[56:59], s10 offen
    s_mov_b64 exec, -1
    s_lshl_b32 s10, s3, 2
    s_add_u32 s10, s10, s9
    s_mul_i32 s11, s10, 43
    s_add_u32 s11, s11, s4
    s_lshl_b32 s11, s11, 11
    s_add_u32 s11, s11, 6291456
    s_lshl_b32 s10, s10, 13
    s_add_u32 s10, s10, 131072
    v_lshlrev_b32 v8, 11, v1
    s_mov_b64 exec, 65535
    buffer_load_dword v31, v28, s[76:79], s11 offen
    s_mov_b64 exec, -1
    s_mov_b64 exec, 7
    buffer_load_dword v31, v8, s[76:79], s10 offen
    s_mov_b64 exec, -1
    s_waitcnt lgkmcnt(9)
    v_pk_mul_f32 v[64:65], v[64:65], v[224:225]
    v_pk_mul_f32 v[66:67], v[66:67], v[226:227]
    s_waitcnt lgkmcnt(8)
    v_pk_mul_f32 v[68:69], v[68:69], v[228:229]
    v_pk_mul_f32 v[70:71], v[70:71], v[230:231]
    v_cvt_pk_bf16_f32 v48, v64, v65
    v_cvt_pk_bf16_f32 v49, v66, v67
    v_cvt_pk_bf16_f32 v50, v68, v69
    v_cvt_pk_bf16_f32 v51, v70, v71
    ds_write_b128 v16, v[48:51] offset:4096
    s_waitcnt lgkmcnt(8)
    v_pk_mul_f32 v[72:73], v[72:73], v[232:233]
    v_pk_mul_f32 v[74:75], v[74:75], v[234:235]
    s_waitcnt lgkmcnt(7)
    v_pk_mul_f32 v[76:77], v[76:77], v[236:237]
    v_pk_mul_f32 v[78:79], v[78:79], v[238:239]
    v_cvt_pk_bf16_f32 v52, v72, v73
    v_cvt_pk_bf16_f32 v53, v74, v75
    v_cvt_pk_bf16_f32 v54, v76, v77
    v_cvt_pk_bf16_f32 v55, v78, v79
    ds_write_b128 v16, v[52:55] offset:5120
    s_waitcnt lgkmcnt(5)
    v_pk_mul_f32 v[80:81], v[80:81], v[240:241]
    v_pk_mul_f32 v[82:83], v[82:83], v[242:243]
    s_waitcnt lgkmcnt(4)
    v_pk_mul_f32 v[84:85], v[84:85], v[244:245]
    v_pk_mul_f32 v[86:87], v[86:87], v[246:247]
    v_cvt_pk_bf16_f32 v56, v80, v81
    v_cvt_pk_bf16_f32 v57, v82, v83
    v_cvt_pk_bf16_f32 v58, v84, v85
    v_cvt_pk_bf16_f32 v59, v86, v87
    ds_write_b128 v16, v[56:59] offset:6144
    s_waitcnt lgkmcnt(4)
    v_pk_mul_f32 v[88:89], v[88:89], v[248:249]
    v_pk_mul_f32 v[90:91], v[90:91], v[250:251]
    s_waitcnt lgkmcnt(3)
    v_pk_mul_f32 v[92:93], v[92:93], v[252:253]
    v_pk_mul_f32 v[94:95], v[94:95], v[254:255]
    v_cvt_pk_bf16_f32 v60, v88, v89
    v_cvt_pk_bf16_f32 v61, v90, v91
    v_cvt_pk_bf16_f32 v62, v92, v93
    v_cvt_pk_bf16_f32 v63, v94, v95
    ds_write_b128 v16, v[60:63] offset:7168
    v_cvt_pk_bf16_f32 v96, v192, v193
    v_cvt_pk_bf16_f32 v97, v194, v195
    v_cvt_pk_bf16_f32 v98, v196, v197
    v_cvt_pk_bf16_f32 v99, v198, v199
    v_cvt_pk_bf16_f32 v100, v200, v201
    v_cvt_pk_bf16_f32 v101, v202, v203
    v_cvt_pk_bf16_f32 v102, v204, v205
    v_cvt_pk_bf16_f32 v103, v206, v207
    v_cvt_pk_bf16_f32 v104, v208, v209
    v_cvt_pk_bf16_f32 v105, v210, v211
    v_cvt_pk_bf16_f32 v106, v212, v213
    v_cvt_pk_bf16_f32 v107, v214, v215
    v_cvt_pk_bf16_f32 v108, v216, v217
    v_cvt_pk_bf16_f32 v109, v218, v219
    v_cvt_pk_bf16_f32 v110, v220, v221
    v_cvt_pk_bf16_f32 v111, v222, v223
    v_cvt_pk_bf16_f32 v112, v224, v225
    v_cvt_pk_bf16_f32 v113, v226, v227
    v_cvt_pk_bf16_f32 v114, v228, v229
    v_cvt_pk_bf16_f32 v115, v230, v231
    v_cvt_pk_bf16_f32 v116, v232, v233
    v_cvt_pk_bf16_f32 v117, v234, v235
    v_cvt_pk_bf16_f32 v118, v236, v237
    v_cvt_pk_bf16_f32 v119, v238, v239
    v_cvt_pk_bf16_f32 v120, v240, v241
    v_cvt_pk_bf16_f32 v121, v242, v243
    v_cvt_pk_bf16_f32 v122, v244, v245
    v_cvt_pk_bf16_f32 v123, v246, v247
    v_cvt_pk_bf16_f32 v124, v248, v249
    v_cvt_pk_bf16_f32 v125, v250, v251
    v_cvt_pk_bf16_f32 v126, v252, v253
    v_cvt_pk_bf16_f32 v127, v254, v255
    ds_read_b32 v6, v4 offset:32
    v_mfma_f32_16x16x32_bf16 v[224:227], v[160:163], v[96:99], 0
    v_mfma_f32_16x16x32_bf16 v[228:231], v[164:167], v[100:103], 0
    v_mfma_f32_16x16x32_bf16 v[224:227], v[168:171], v[104:107], v[224:227]
    v_mfma_f32_16x16x32_bf16 v[228:231], v[172:175], v[108:111], v[228:231]
    v_mfma_f32_16x16x32_bf16 v[224:227], v[176:179], v[112:115], v[224:227]
    v_mfma_f32_16x16x32_bf16 v[228:231], v[180:183], v[116:119], v[228:231]
    v_mfma_f32_16x16x32_bf16 v[224:227], v[184:187], v[120:123], v[224:227]
    v_mfma_f32_16x16x32_bf16 v[228:231], v[188:191], v[124:127], v[228:231]
    s_nop 7
    v_add_f32 v224, v224, v228
    v_add_f32 v225, v225, v229
    v_add_f32 v226, v226, v230
    v_add_f32 v227, v227, v231
    v_cvt_pk_bf16_f32 v8, v224, v226
    v_and_b32 v9, 0xffff0000, v8
    v_sub_f32 v9, v226, v9
    v_cvt_pk_bf16_f32 v9, v226, v9
    v_cvt_pk_bf16_f32 v10, v225, v227
    v_and_b32 v11, 0xffff0000, v10
    v_sub_f32 v11, v227, v11
    v_cvt_pk_bf16_f32 v11, v227, v11
    s_mov_b64 exec, 0xffff
    ds_write_b64 v19, v[8:9] offset:10240
    ds_write_b64 v19, v[10:11] offset:10496
    s_mov_b64 exec, 1
    ds_write_b8 v0, v5 offset:24
    s_mov_b64 exec, -1
    s_waitcnt lgkmcnt(3)
    v_cmp_eq_u32 vcc, s96, v6
    s_cbranch_vccnz F_109
F_108:
    ds_read_b32 v6, v4 offset:32
    s_add_u32 s84, s84, 1
    s_waitcnt lgkmcnt(0)
    v_cmp_ne_u32 vcc, s96, v6
    s_cmp_gt_u32 s84, 200000
    s_cbranch_scc1 F_109
    s_cbranch_vccnz F_108
F_109:
    s_add_u32 s10, s99, 0
    s_and_b32 s10, s10, 7
    s_lshl_b32 s10, s10, 10
    s_add_u32 s10, s10, s86
    s_add_u32 m0, s10, 131072
    s_lshl_b32 s10, s10, 3
    s_add_u32 s10, s10, 262144
    buffer_load_dwordx4 v12, s[52:55], s10 offen lds
    s_add_u32 s10, s99, 1
    s_and_b32 s10, s10, 7
    s_lshl_b32 s10, s10, 10
    s_add_u32 s10, s10, s86
    s_add_u32 m0, s10, 131072
    s_lshl_b32 s10, s10, 3
    s_add_u32 s10, s10, 262144
    buffer_load_dwordx4 v12, s[52:55], s10 offen lds
    s_add_u32 s10, s99, 2
    s_and_b32 s10, s10, 7
    s_lshl_b32 s10, s10, 10
    s_add_u32 s10, s10, s86
    s_add_u32 m0, s10, 131072
    s_lshl_b32 s10, s10, 3
    s_add_u32 s10, s10, 262144
    buffer_load_dwordx4 v12, s[52:55], s10 offen lds
    s_add_u32 s10, s99, 3
    s_and_b32 s10, s10, 7
    s_lshl_b32 s10, s10, 10
    s_add_u32 s10, s10, s86
    s_add_u32 m0, s10, 131072
    s_lshl_b32 s10, s10, 3
    s_add_u32 s10, s10, 262144
    buffer_load_dwordx4 v12, s[52:55], s10 offen lds
    s_add_u32 s10, s99, 4
    s_and_b32 s10, s10, 7
    s_lshl_b32 s10, s10, 10
    s_add_u32 s10, s10, s86
    s_add_u32 m0, s10, 131072
    s_lshl_b32 s10, s10, 3
    s_add_u32 s10, s10, 262144
    buffer_load_dwordx4 v12, s[52:55], s10 offen lds
    s_add_u32 s10, s99, 5
    s_and_b32 s10, s10, 7
    s_lshl_b32 s10, s10, 10
    s_add_u32 s10, s10, s86
    s_add_u32 m0, s10, 131072
    s_lshl_b32 s10, s10, 3
    s_add_u32 s10, s10, 262144
    buffer_load_dwordx4 v12, s[52:55], s10 offen lds
    s_add_u32 s10, s99, 6
    s_and_b32 s10, s10, 7
    s_lshl_b32 s10, s10, 10
    s_add_u32 s10, s10, s86
    s_add_u32 m0, s10, 131072
    s_lshl_b32 s10, s10, 3
    s_add_u32 s10, s10, 262144
    buffer_load_dwordx4 v12, s[52:55], s10 offen lds
    s_add_u32 s10, s99, 7
    s_and_b32 s10, s10, 7
    s_lshl_b32 s10, s10, 10
    s_add_u32 s10, s10, s86
    s_add_u32 m0, s10, 131072
    s_lshl_b32 s10, s10, 3
    s_add_u32 s10, s10, 262144
    buffer_load_dwordx4 v12, s[52:55], s10 offen lds
    s_lshl_b32 s10, s4, 2
    s_add_u32 s10, s10, s9
    s_lshl_b32 s10, s10, 14
    s_and_b32 s11, s3, 1
    s_lshl_b32 s11, s11, 13
    s_add_u32 s10, s10, s11
    s_add_u32 s64, s10, 1048576
    s_add_u32 s65, s10, 1052672
    s_xor_b32 s66, s64, 8192
    s_xor_b32 s67, s65, 8192
    v_and_b32 v10, 15, v1
    v_lshrrev_b32 v11, 4, v1
    v_mul_u32_u24 v14, 80, v10
    v_lshl_add_u32 v14, v11, 3, v14
    s_lshr_b32 s10, s9, 1
    s_mul_i32 s10, s10, 1280
    s_and_b32 s11, s9, 1
    s_lshl_b32 s11, s11, 5
    s_add_u32 s10, s10, s11
    v_add_u32 v14, s10, v14
    v_and_b32 v10, 3, v10
    v_lshlrev_b32 v10, 1, v10
    v_lshl_add_u32 v10, v11, 3, v10
    s_lshl_b32 s10, s9, 5
    v_add_u32 v15, s10, v10
    ds_read_b32 v6, v4 offset:108
    s_waitcnt lgkmcnt(0)
    v_cmp_eq_u32 vcc, s96, v6
    s_cbranch_vccnz F_111
F_110:
    ds_read_b32 v6, v4 offset:108
    s_add_u32 s84, s84, 1
    s_waitcnt lgkmcnt(0)
    v_cmp_ne_u32 vcc, s96, v6
    s_cmp_gt_u32 s84, 200000
    s_cbranch_scc1 F_111
    s_cbranch_vccnz F_110
F_111:
    buffer_load_dwordx4 v[64:67], v2, s[76:79], s64 offen offset:0
    buffer_load_dwordx4 v[68:71], v2, s[76:79], s64 offen offset:1024
    buffer_load_dwordx4 v[72:75], v2, s[76:79], s64 offen offset:2048
    buffer_load_dwordx4 v[76:79], v2, s[76:79], s64 offen offset:3072
    buffer_load_dwordx4 v[80:83], v2, s[76:79], s65 offen offset:0
    buffer_load_dwordx4 v[84:87], v2, s[76:79], s65 offen offset:1024
    buffer_load_dwordx4 v[88:91], v2, s[76:79], s65 offen offset:2048
    buffer_load_dwordx4 v[92:95], v2, s[76:79], s65 offen offset:3072
    s_waitcnt vmcnt(8)
    s_mov_b64 exec, 1
    ds_write_b8 v0, v5 offset:44
    s_mov_b64 exec, -1
    buffer_load_dwordx4 v[96:99], v2, s[76:79], s66 offen offset:0
    buffer_load_dwordx4 v[100:103], v2, s[76:79], s66 offen offset:1024
    buffer_load_dwordx4 v[104:107], v2, s[76:79], s66 offen offset:2048
    buffer_load_dwordx4 v[108:111], v2, s[76:79], s66 offen offset:3072
    buffer_load_dwordx4 v[112:115], v2, s[76:79], s67 offen offset:0
    buffer_load_dwordx4 v[116:119], v2, s[76:79], s67 offen offset:1024
    buffer_load_dwordx4 v[120:123], v2, s[76:79], s67 offen offset:2048
    buffer_load_dwordx4 v[124:127], v2, s[76:79], s67 offen offset:3072
    s_mov_b32 s14, 655360
    s_mov_b32 s15, 659456
    buffer_load_dwordx4 v[128:131], v20, s[76:79], s14 offen offset:0
    buffer_load_dwordx4 v[132:135], v20, s[76:79], s14 offen offset:2048
    buffer_load_dwordx4 v[136:139], v20, s[76:79], s15 offen offset:0
    buffer_load_dwordx4 v[140:143], v20, s[76:79], s15 offen offset:2048
    buffer_load_dwordx4 v[144:147], v23, s[76:79], s14 offen offset:0
    buffer_load_dwordx4 v[148:151], v23, s[76:79], s14 offen offset:2048
    buffer_load_dwordx4 v[152:155], v23, s[76:79], s15 offen offset:0
    buffer_load_dwordx4 v[156:159], v23, s[76:79], s15 offen offset:2048
    v_add_u32 v8, 0, v1
    v_mul_u32_u24 v9, 0x1556, v8
    v_lshrrev_b32 v9, 16, v9
    v_mul_u32_u24 v10, 2560, v9
    v_lshl_add_u32 v13, v8, 4, v10
    v_add_u32 v8, 64, v1
    v_mul_u32_u24 v9, 0x1556, v8
    v_lshrrev_b32 v9, 16, v9
    v_mul_u32_u24 v10, 2560, v9
    v_lshl_add_u32 v17, v8, 4, v10
    v_add_u32 v8, 128, v1
    v_mul_u32_u24 v9, 0x1556, v8
    v_lshrrev_b32 v9, 16, v9
    v_mul_u32_u24 v10, 2560, v9
    v_lshl_add_u32 v22, v8, 4, v10
    s_mul_i32 s87, s9, 352256
    s_lshl_b32 s11, s82, 5
    s_add_u32 s87, s87, s11
    s_and_b32 s11, s3, 1
    s_mul_i32 s12, s11, 176128
    s_add_u32 s70, s87, s12
    s_sub_u32 s71, s87, s12
    s_mul_i32 s10, s9, 24576
    s_add_u32 s10, s10, 20480
    s_mul_i32 s11, s11, 12288
    s_add_u32 s68, s10, s11
    s_sub_u32 s69, s10, s11
    s_mov_b32 s12, 0x3f80
    s_mov_b32 s13, 0x3f800000
    v_mov_b32 v192, 0
    v_mov_b32 v193, 0
    v_mov_b32 v194, 0
    v_mov_b32 v195, 0
    v_mov_b32 v196, 0
    v_mov_b32 v197, 0
    s_waitcnt vmcnt(23)
    v_dot2c_f32_bf16 v192, s12, v64
    v_dot2c_f32_bf16 v193, s13, v64
    v_dot2c_f32_bf16 v194, s12, v65
    v_dot2c_f32_bf16 v195, s13, v65
    v_add_f32 v196, v196, v66
    v_bitop3_b32 v197, v197, v67, s6 bitop3:0xf6
    s_waitcnt vmcnt(22)
    v_dot2c_f32_bf16 v192, s12, v68
    v_dot2c_f32_bf16 v193, s13, v68
    v_dot2c_f32_bf16 v194, s12, v69
    v_dot2c_f32_bf16 v195, s13, v69
    v_add_f32 v196, v196, v70
    v_bitop3_b32 v197, v197, v71, s6 bitop3:0xf6
    s_waitcnt vmcnt(21)
    v_dot2c_f32_bf16 v192, s12, v72
    v_dot2c_f32_bf16 v193, s13, v72
    v_dot2c_f32_bf16 v194, s12, v73
    v_dot2c_f32_bf16 v195, s13, v73
    v_add_f32 v196, v196, v74
    v_bitop3_b32 v197, v197, v75, s6 bitop3:0xf6
    s_waitcnt vmcnt(20)
    v_dot2c_f32_bf16 v192, s12, v76
    v_dot2c_f32_bf16 v193, s13, v76
    v_dot2c_f32_bf16 v194, s12, v77
    v_dot2c_f32_bf16 v195, s13, v77
    v_add_f32 v196, v196, v78
    v_bitop3_b32 v197, v197, v79, s6 bitop3:0xf6
    s_waitcnt vmcnt(19)
    v_dot2c_f32_bf16 v192, s12, v80
    v_dot2c_f32_bf16 v193, s13, v80
    v_dot2c_f32_bf16 v194, s12, v81
    v_dot2c_f32_bf16 v195, s13, v81
    v_add_f32 v196, v196, v82
    v_bitop3_b32 v197, v197, v83, s6 bitop3:0xf6
    s_waitcnt vmcnt(18)
    v_dot2c_f32_bf16 v192, s12, v84
    v_dot2c_f32_bf16 v193, s13, v84
    v_dot2c_f32_bf16 v194, s12, v85
    v_dot2c_f32_bf16 v195, s13, v85
    v_add_f32 v196, v196, v86
    v_bitop3_b32 v197, v197, v87, s6 bitop3:0xf6
    s_waitcnt vmcnt(17)
    v_dot2c_f32_bf16 v192, s12, v88
    v_dot2c_f32_bf16 v193, s13, v88
    v_dot2c_f32_bf16 v194, s12, v89
    v_dot2c_f32_bf16 v195, s13, v89
    v_add_f32 v196, v196, v90
    v_bitop3_b32 v197, v197, v91, s6 bitop3:0xf6
    s_waitcnt vmcnt(16)
    v_dot2c_f32_bf16 v192, s12, v92
    v_dot2c_f32_bf16 v193, s13, v92
    v_dot2c_f32_bf16 v194, s12, v93
    v_dot2c_f32_bf16 v195, s13, v93
    v_add_f32 v196, v196, v94
    v_bitop3_b32 v197, v197, v95, s6 bitop3:0xf6
    s_waitcnt vmcnt(15)
    v_dot2c_f32_bf16 v192, s12, v96
    v_dot2c_f32_bf16 v193, s13, v96
    v_dot2c_f32_bf16 v194, s12, v97
    v_dot2c_f32_bf16 v195, s13, v97
    v_add_f32 v196, v196, v98
    v_bitop3_b32 v197, v197, v99, s6 bitop3:0xf6
    s_waitcnt vmcnt(14)
    v_dot2c_f32_bf16 v192, s12, v100
    v_dot2c_f32_bf16 v193, s13, v100
    v_dot2c_f32_bf16 v194, s12, v101
    v_dot2c_f32_bf16 v195, s13, v101
    v_add_f32 v196, v196, v102
    v_bitop3_b32 v197, v197, v103, s6 bitop3:0xf6
    s_waitcnt vmcnt(13)
    v_dot2c_f32_bf16 v192, s12, v104
    v_dot2c_f32_bf16 v193, s13, v104
    v_dot2c_f32_bf16 v194, s12, v105
    v_dot2c_f32_bf16 v195, s13, v105
    v_add_f32 v196, v196, v106
    v_bitop3_b32 v197, v197, v107, s6 bitop3:0xf6
    s_waitcnt vmcnt(12)
    v_dot2c_f32_bf16 v192, s12, v108
    v_dot2c_f32_bf16 v193, s13, v108
    v_dot2c_f32_bf16 v194, s12, v109
    v_dot2c_f32_bf16 v195, s13, v109
    v_add_f32 v196, v196, v110
    v_bitop3_b32 v197, v197, v111, s6 bitop3:0xf6
    s_waitcnt vmcnt(11)
    v_dot2c_f32_bf16 v192, s12, v112
    v_dot2c_f32_bf16 v193, s13, v112
    v_dot2c_f32_bf16 v194, s12, v113
    v_dot2c_f32_bf16 v195, s13, v113
    v_add_f32 v196, v196, v114
    v_bitop3_b32 v197, v197, v115, s6 bitop3:0xf6
    s_waitcnt vmcnt(10)
    v_dot2c_f32_bf16 v192, s12, v116
    v_dot2c_f32_bf16 v193, s13, v116
    v_dot2c_f32_bf16 v194, s12, v117
    v_dot2c_f32_bf16 v195, s13, v117
    v_add_f32 v196, v196, v118
    v_bitop3_b32 v197, v197, v119, s6 bitop3:0xf6
    s_waitcnt vmcnt(9)
    v_dot2c_f32_bf16 v192, s12, v120
    v_dot2c_f32_bf16 v193, s13, v120
    v_dot2c_f32_bf16 v194, s12, v121
    v_dot2c_f32_bf16 v195, s13, v121
    v_add_f32 v196, v196, v122
    v_bitop3_b32 v197, v197, v123, s6 bitop3:0xf6
    s_waitcnt vmcnt(8)
    v_dot2c_f32_bf16 v192, s12, v124
    v_dot2c_f32_bf16 v193, s13, v124
    v_dot2c_f32_bf16 v194, s12, v125
    v_dot2c_f32_bf16 v195, s13, v125
    v_add_f32 v196, v196, v126
    v_bitop3_b32 v197, v197, v127, s6 bitop3:0xf6
    v_cmp_ne_u32 vcc, 0, v197
    s_cbranch_vccz G_115
G_114:
    s_cmp_gt_u32 s84, 200000
    s_cbranch_scc1 G_115
G_112:
    s_mov_b32 s10, 0
    v_cmp_ne_u32 vcc, s6, v67
    s_cbranch_vccz G_116
    buffer_load_dwordx4 v[64:67], v2, s[76:79], s64 offen offset:0 sc1
    s_mov_b32 s10, 1
G_116:
    v_cmp_ne_u32 vcc, s6, v71
    s_cbranch_vccz G_117
    buffer_load_dwordx4 v[68:71], v2, s[76:79], s64 offen offset:1024 sc1
    s_mov_b32 s10, 1
G_117:
    v_cmp_ne_u32 vcc, s6, v75
    s_cbranch_vccz G_118
    buffer_load_dwordx4 v[72:75], v2, s[76:79], s64 offen offset:2048 sc1
    s_mov_b32 s10, 1
G_118:
    v_cmp_ne_u32 vcc, s6, v79
    s_cbranch_vccz G_119
    buffer_load_dwordx4 v[76:79], v2, s[76:79], s64 offen offset:3072 sc1
    s_mov_b32 s10, 1
G_119:
    v_cmp_ne_u32 vcc, s6, v83
    s_cbranch_vccz G_120
    buffer_load_dwordx4 v[80:83], v2, s[76:79], s65 offen offset:0 sc1
    s_mov_b32 s10, 1
G_120:
    v_cmp_ne_u32 vcc, s6, v87
    s_cbranch_vccz G_121
    buffer_load_dwordx4 v[84:87], v2, s[76:79], s65 offen offset:1024 sc1
    s_mov_b32 s10, 1
G_121:
    v_cmp_ne_u32 vcc, s6, v91
    s_cbranch_vccz G_122
    buffer_load_dwordx4 v[88:91], v2, s[76:79], s65 offen offset:2048 sc1
    s_mov_b32 s10, 1
G_122:
    v_cmp_ne_u32 vcc, s6, v95
    s_cbranch_vccz G_123
    buffer_load_dwordx4 v[92:95], v2, s[76:79], s65 offen offset:3072 sc1
    s_mov_b32 s10, 1
G_123:
    v_cmp_ne_u32 vcc, s6, v99
    s_cbranch_vccz G_124
    buffer_load_dwordx4 v[96:99], v2, s[76:79], s66 offen offset:0 sc1
    s_mov_b32 s10, 1
G_124:
    v_cmp_ne_u32 vcc, s6, v103
    s_cbranch_vccz G_125
    buffer_load_dwordx4 v[100:103], v2, s[76:79], s66 offen offset:1024 sc1
    s_mov_b32 s10, 1
G_125:
    v_cmp_ne_u32 vcc, s6, v107
    s_cbranch_vccz G_126
    buffer_load_dwordx4 v[104:107], v2, s[76:79], s66 offen offset:2048 sc1
    s_mov_b32 s10, 1
G_126:
    v_cmp_ne_u32 vcc, s6, v111
    s_cbranch_vccz G_127
    buffer_load_dwordx4 v[108:111], v2, s[76:79], s66 offen offset:3072 sc1
    s_mov_b32 s10, 1
G_127:
    v_cmp_ne_u32 vcc, s6, v115
    s_cbranch_vccz G_128
    buffer_load_dwordx4 v[112:115], v2, s[76:79], s67 offen offset:0 sc1
    s_mov_b32 s10, 1
G_128:
    v_cmp_ne_u32 vcc, s6, v119
    s_cbranch_vccz G_129
    buffer_load_dwordx4 v[116:119], v2, s[76:79], s67 offen offset:1024 sc1
    s_mov_b32 s10, 1
G_129:
    v_cmp_ne_u32 vcc, s6, v123
    s_cbranch_vccz G_130
    buffer_load_dwordx4 v[120:123], v2, s[76:79], s67 offen offset:2048 sc1
    s_mov_b32 s10, 1
G_130:
    v_cmp_ne_u32 vcc, s6, v127
    s_cbranch_vccz G_131
    buffer_load_dwordx4 v[124:127], v2, s[76:79], s67 offen offset:3072 sc1
    s_mov_b32 s10, 1
G_131:
    s_add_u32 s84, s84, 8
    s_waitcnt vmcnt(0)
    v_mov_b32 v192, 0
    v_mov_b32 v193, 0
    v_mov_b32 v194, 0
    v_mov_b32 v195, 0
    v_mov_b32 v196, 0
    v_mov_b32 v197, 0
    v_dot2c_f32_bf16 v192, s12, v64
    v_dot2c_f32_bf16 v193, s13, v64
    v_dot2c_f32_bf16 v194, s12, v65
    v_dot2c_f32_bf16 v195, s13, v65
    v_add_f32 v196, v196, v66
    v_bitop3_b32 v197, v197, v67, s6 bitop3:0xf6
    v_dot2c_f32_bf16 v192, s12, v68
    v_dot2c_f32_bf16 v193, s13, v68
    v_dot2c_f32_bf16 v194, s12, v69
    v_dot2c_f32_bf16 v195, s13, v69
    v_add_f32 v196, v196, v70
    v_bitop3_b32 v197, v197, v71, s6 bitop3:0xf6
    v_dot2c_f32_bf16 v192, s12, v72
    v_dot2c_f32_bf16 v193, s13, v72
    v_dot2c_f32_bf16 v194, s12, v73
    v_dot2c_f32_bf16 v195, s13, v73
    v_add_f32 v196, v196, v74
    v_bitop3_b32 v197, v197, v75, s6 bitop3:0xf6
    v_dot2c_f32_bf16 v192, s12, v76
    v_dot2c_f32_bf16 v193, s13, v76
    v_dot2c_f32_bf16 v194, s12, v77
    v_dot2c_f32_bf16 v195, s13, v77
    v_add_f32 v196, v196, v78
    v_bitop3_b32 v197, v197, v79, s6 bitop3:0xf6
    v_dot2c_f32_bf16 v192, s12, v80
    v_dot2c_f32_bf16 v193, s13, v80
    v_dot2c_f32_bf16 v194, s12, v81
    v_dot2c_f32_bf16 v195, s13, v81
    v_add_f32 v196, v196, v82
    v_bitop3_b32 v197, v197, v83, s6 bitop3:0xf6
    v_dot2c_f32_bf16 v192, s12, v84
    v_dot2c_f32_bf16 v193, s13, v84
    v_dot2c_f32_bf16 v194, s12, v85
    v_dot2c_f32_bf16 v195, s13, v85
    v_add_f32 v196, v196, v86
    v_bitop3_b32 v197, v197, v87, s6 bitop3:0xf6
    v_dot2c_f32_bf16 v192, s12, v88
    v_dot2c_f32_bf16 v193, s13, v88
    v_dot2c_f32_bf16 v194, s12, v89
    v_dot2c_f32_bf16 v195, s13, v89
    v_add_f32 v196, v196, v90
    v_bitop3_b32 v197, v197, v91, s6 bitop3:0xf6
    v_dot2c_f32_bf16 v192, s12, v92
    v_dot2c_f32_bf16 v193, s13, v92
    v_dot2c_f32_bf16 v194, s12, v93
    v_dot2c_f32_bf16 v195, s13, v93
    v_add_f32 v196, v196, v94
    v_bitop3_b32 v197, v197, v95, s6 bitop3:0xf6
    v_dot2c_f32_bf16 v192, s12, v96
    v_dot2c_f32_bf16 v193, s13, v96
    v_dot2c_f32_bf16 v194, s12, v97
    v_dot2c_f32_bf16 v195, s13, v97
    v_add_f32 v196, v196, v98
    v_bitop3_b32 v197, v197, v99, s6 bitop3:0xf6
    v_dot2c_f32_bf16 v192, s12, v100
    v_dot2c_f32_bf16 v193, s13, v100
    v_dot2c_f32_bf16 v194, s12, v101
    v_dot2c_f32_bf16 v195, s13, v101
    v_add_f32 v196, v196, v102
    v_bitop3_b32 v197, v197, v103, s6 bitop3:0xf6
    v_dot2c_f32_bf16 v192, s12, v104
    v_dot2c_f32_bf16 v193, s13, v104
    v_dot2c_f32_bf16 v194, s12, v105
    v_dot2c_f32_bf16 v195, s13, v105
    v_add_f32 v196, v196, v106
    v_bitop3_b32 v197, v197, v107, s6 bitop3:0xf6
    v_dot2c_f32_bf16 v192, s12, v108
    v_dot2c_f32_bf16 v193, s13, v108
    v_dot2c_f32_bf16 v194, s12, v109
    v_dot2c_f32_bf16 v195, s13, v109
    v_add_f32 v196, v196, v110
    v_bitop3_b32 v197, v197, v111, s6 bitop3:0xf6
    v_dot2c_f32_bf16 v192, s12, v112
    v_dot2c_f32_bf16 v193, s13, v112
    v_dot2c_f32_bf16 v194, s12, v113
    v_dot2c_f32_bf16 v195, s13, v113
    v_add_f32 v196, v196, v114
    v_bitop3_b32 v197, v197, v115, s6 bitop3:0xf6
    v_dot2c_f32_bf16 v192, s12, v116
    v_dot2c_f32_bf16 v193, s13, v116
    v_dot2c_f32_bf16 v194, s12, v117
    v_dot2c_f32_bf16 v195, s13, v117
    v_add_f32 v196, v196, v118
    v_bitop3_b32 v197, v197, v119, s6 bitop3:0xf6
    v_dot2c_f32_bf16 v192, s12, v120
    v_dot2c_f32_bf16 v193, s13, v120
    v_dot2c_f32_bf16 v194, s12, v121
    v_dot2c_f32_bf16 v195, s13, v121
    v_add_f32 v196, v196, v122
    v_bitop3_b32 v197, v197, v123, s6 bitop3:0xf6
    v_dot2c_f32_bf16 v192, s12, v124
    v_dot2c_f32_bf16 v193, s13, v124
    v_dot2c_f32_bf16 v194, s12, v125
    v_dot2c_f32_bf16 v195, s13, v125
    v_add_f32 v196, v196, v126
    v_bitop3_b32 v197, v197, v127, s6 bitop3:0xf6
    v_cmp_ne_u32 vcc, 0, v197
    s_cbranch_vccnz G_114
    s_nop 4
G_115:
    v_cvt_pk_bf16_f32 v8, v192, v193
    v_cvt_pk_bf16_f32 v9, v194, v195
    v_cvt_pk_bf16_f32 v10, v196, v196
    ds_write_b64 v14, v[8:9] offset:4096
    ds_write_b16 v15, v10 offset:6656
    s_mov_b64 exec, 1
    ds_write_b8 v0, v5 offset:52
    s_mov_b64 exec, -1
    ds_read_b32 v6, v4 offset:40
    ds_read_b32 v7, v4 offset:48
    s_lshr_b32 s10, s9, 1
    s_mul_i32 s85, s10, 704512
    s_and_b32 s11, s9, 1
    s_lshl_b32 s14, s11, 13
    s_add_u32 s85, s85, s14
    s_lshl_b32 s11, s11, 10
    s_mul_i32 s86, s10, 22528
    s_add_u32 s86, s86, s11
    s_mul_i32 s99, s10, 49152
    s_add_u32 s99, s99, s11
    s_and_b32 s12, s3, 1
    s_lshl_b32 s12, s12, 1
    s_lshr_b32 s13, s4, 3
    s_add_u32 s12, s12, s13
    s_mul_i32 s13, s12, 180224
    s_add_u32 s64, s85, s13
    s_sub_u32 s13, s64, 704512
    s_cmp_ge_u32 s12, 3
    s_cselect_b32 s65, s13, s64
    s_cmp_ge_u32 s12, 2
    s_cselect_b32 s66, s13, s64
    s_cmp_ge_u32 s12, 1
    s_cselect_b32 s67, s13, s64
    s_mov_b64 exec, 65535
    buffer_load_dword v31, v28, s[72:75], s94 offen
    s_mov_b64 exec, -1
    s_mov_b64 exec, 3
    buffer_load_dword v31, v28, s[76:79], s95 offen
    s_mov_b64 exec, -1
    s_waitcnt lgkmcnt(1)
    v_cmp_eq_u32 vcc, s96, v6
    s_cbranch_vccnz F_133
F_132:
    ds_read_b32 v6, v4 offset:40
    s_add_u32 s84, s84, 1
    s_waitcnt lgkmcnt(0)
    v_cmp_ne_u32 vcc, s96, v6
    s_cmp_gt_u32 s84, 200000
    s_cbranch_scc1 F_133
    s_cbranch_vccnz F_132
F_133:
    s_waitcnt lgkmcnt(0)
    v_cmp_eq_u32 vcc, s96, v7
    s_cbranch_vccnz F_135
F_134:
    ds_read_b32 v7, v4 offset:48
    s_add_u32 s84, s84, 1
    s_waitcnt lgkmcnt(0)
    v_cmp_ne_u32 vcc, s96, v7
    s_cmp_gt_u32 s84, 200000
    s_cbranch_scc1 F_135
    s_cbranch_vccnz F_134
F_135:
    s_waitcnt vmcnt(6)
    s_add_u32 s10, s70, 0
    s_add_u32 m0, s68, 0
    s_nop 0
    buffer_load_dwordx4 v13, s[56:59], s10 offen lds
    s_waitcnt vmcnt(6)
    s_add_u32 m0, s68, 1024
    s_nop 0
    buffer_load_dwordx4 v17, s[56:59], s10 offen lds
    s_waitcnt vmcnt(6)
    s_add_u32 m0, s68, 2048
    s_nop 0
    buffer_load_dwordx4 v22, s[56:59], s10 offen lds
    s_waitcnt vmcnt(6)
    s_add_u32 s10, s70, 44032
    s_add_u32 m0, s68, 3072
    s_nop 0
    buffer_load_dwordx4 v13, s[56:59], s10 offen lds
    s_waitcnt vmcnt(6)
    s_add_u32 m0, s68, 4096
    s_nop 0
    buffer_load_dwordx4 v17, s[56:59], s10 offen lds
    s_waitcnt vmcnt(6)
    s_add_u32 m0, s68, 5120
    s_nop 0
    buffer_load_dwordx4 v22, s[56:59], s10 offen lds
    s_waitcnt vmcnt(6)
    s_add_u32 s10, s70, 88064
    s_add_u32 m0, s68, 6144
    s_nop 0
    buffer_load_dwordx4 v13, s[56:59], s10 offen lds
    s_waitcnt vmcnt(6)
    s_add_u32 m0, s68, 7168
    s_nop 0
    buffer_load_dwordx4 v17, s[56:59], s10 offen lds
    s_waitcnt vmcnt(17)
    v_perm_b32 v8, v129, v128, s89
    v_perm_b32 v9, v131, v130, s90
    v_bitop3_b32 v10, v8, v9, s6 bitop3:0x56
    s_waitcnt vmcnt(16)
    v_perm_b32 v8, v133, v132, s89
    v_perm_b32 v9, v135, v134, s90
    v_bitop3_b32 v8, v8, v9, s6 bitop3:0x56
    v_or_b32 v10, v10, v8
    s_waitcnt vmcnt(15)
    v_perm_b32 v8, v137, v136, s89
    v_perm_b32 v9, v139, v138, s90
    v_bitop3_b32 v8, v8, v9, s6 bitop3:0x56
    v_or_b32 v10, v10, v8
    s_waitcnt vmcnt(14)
    v_perm_b32 v8, v141, v140, s89
    v_perm_b32 v9, v143, v142, s90
    v_bitop3_b32 v8, v8, v9, s6 bitop3:0x56
    v_or_b32 v10, v10, v8
    s_waitcnt vmcnt(13)
    v_perm_b32 v8, v145, v144, s89
    v_perm_b32 v9, v147, v146, s90
    v_bitop3_b32 v8, v8, v9, s6 bitop3:0x56
    v_or_b32 v10, v10, v8
    s_waitcnt vmcnt(12)
    v_perm_b32 v8, v149, v148, s89
    v_perm_b32 v9, v151, v150, s90
    v_bitop3_b32 v8, v8, v9, s6 bitop3:0x56
    v_or_b32 v10, v10, v8
    s_waitcnt vmcnt(11)
    v_perm_b32 v8, v153, v152, s89
    v_perm_b32 v9, v155, v154, s90
    v_bitop3_b32 v8, v8, v9, s6 bitop3:0x56
    v_or_b32 v10, v10, v8
    s_waitcnt vmcnt(10)
    v_perm_b32 v8, v157, v156, s89
    v_perm_b32 v9, v159, v158, s90
    v_bitop3_b32 v8, v8, v9, s6 bitop3:0x56
    v_or_b32 v10, v10, v8
    v_cmp_ne_u32 vcc, 0, v10
    s_cbranch_vccz L_136
M_137:
    s_add_u32 s84, s84, 8
    s_waitcnt vmcnt(0)
    s_mov_b64 exec, -1
    v_perm_b32 v8, v129, v128, s89
    v_perm_b32 v9, v131, v130, s90
    v_bitop3_b32 v10, v8, v9, s6 bitop3:0x56
    v_perm_b32 v8, v133, v132, s89
    v_perm_b32 v9, v135, v134, s90
    v_bitop3_b32 v8, v8, v9, s6 bitop3:0x56
    v_or_b32 v10, v10, v8
    v_perm_b32 v8, v137, v136, s89
    v_perm_b32 v9, v139, v138, s90
    v_bitop3_b32 v8, v8, v9, s6 bitop3:0x56
    v_or_b32 v10, v10, v8
    v_perm_b32 v8, v141, v140, s89
    v_perm_b32 v9, v143, v142, s90
    v_bitop3_b32 v8, v8, v9, s6 bitop3:0x56
    v_or_b32 v10, v10, v8
    v_perm_b32 v8, v145, v144, s89
    v_perm_b32 v9, v147, v146, s90
    v_bitop3_b32 v8, v8, v9, s6 bitop3:0x56
    v_or_b32 v10, v10, v8
    v_perm_b32 v8, v149, v148, s89
    v_perm_b32 v9, v151, v150, s90
    v_bitop3_b32 v8, v8, v9, s6 bitop3:0x56
    v_or_b32 v10, v10, v8
    v_perm_b32 v8, v153, v152, s89
    v_perm_b32 v9, v155, v154, s90
    v_bitop3_b32 v8, v8, v9, s6 bitop3:0x56
    v_or_b32 v10, v10, v8
    v_perm_b32 v8, v157, v156, s89
    v_perm_b32 v9, v159, v158, s90
    v_bitop3_b32 v8, v8, v9, s6 bitop3:0x56
    v_or_b32 v10, v10, v8
    v_cmp_ne_u32 vcc, 0, v10
    s_cmp_gt_u32 s84, 200000
    s_cbranch_scc1 M_138
    s_cbranch_vccz M_138
    s_mov_b64 exec, vcc
    s_mov_b32 s14, 655360
    s_mov_b32 s15, 659456
    buffer_load_dwordx4 v[128:131], v20, s[76:79], s14 offen offset:0 sc1
    buffer_load_dwordx4 v[132:135], v20, s[76:79], s14 offen offset:2048 sc1
    buffer_load_dwordx4 v[136:139], v20, s[76:79], s15 offen offset:0 sc1
    buffer_load_dwordx4 v[140:143], v20, s[76:79], s15 offen offset:2048 sc1
    buffer_load_dwordx4 v[144:147], v23, s[76:79], s14 offen offset:0 sc1
    buffer_load_dwordx4 v[148:151], v23, s[76:79], s14 offen offset:2048 sc1
    buffer_load_dwordx4 v[152:155], v23, s[76:79], s15 offen offset:0 sc1
    buffer_load_dwordx4 v[156:159], v23, s[76:79], s15 offen offset:2048 sc1
    s_branch M_137
M_138:
L_136:
    v_and_b32 v144, 0xffffff00, v144
    v_and_b32 v145, 0xffffff00, v145
    v_and_b32 v146, 0xffffff00, v146
    v_and_b32 v147, 0xffffff00, v147
    v_and_b32 v148, 0xffffff00, v148
    v_and_b32 v149, 0xffffff00, v149
    v_and_b32 v150, 0xffffff00, v150
    v_and_b32 v151, 0xffffff00, v151
    v_and_b32 v152, 0xffffff00, v152
    v_and_b32 v153, 0xffffff00, v153
    v_and_b32 v154, 0xffffff00, v154
    v_and_b32 v155, 0xffffff00, v155
    v_and_b32 v156, 0xffffff00, v156
    v_and_b32 v157, 0xffffff00, v157
    v_and_b32 v158, 0xffffff00, v158
    v_and_b32 v159, 0xffffff00, v159
    v_pk_add_f32 v[144:145], v[144:145], v[148:149]
    v_pk_add_f32 v[146:147], v[146:147], v[150:151]
    v_pk_add_f32 v[152:153], v[152:153], v[156:157]
    v_pk_add_f32 v[154:155], v[154:155], v[158:159]
    v_pk_add_f32 v[144:145], v[144:145], v[152:153]
    v_pk_add_f32 v[146:147], v[146:147], v[154:155]
    v_cvt_pk_bf16_f32 v148, v144, v145
    v_cvt_pk_bf16_f32 v149, v146, v147
    v_lshlrev_b32 v144, 16, v148
    v_and_b32 v145, 0xffff0000, v148
    v_lshlrev_b32 v146, 16, v149
    v_and_b32 v147, 0xffff0000, v149
    v_add_f32 v144, v29, v144
    v_add_f32 v145, v29, v145
    v_add_f32 v146, v29, v146
    v_add_f32 v147, v29, v147
    v_cvt_pk_bf16_f32 v144, v144, v144
    v_and_b32 v144, 0xffff0000, v144
    v_cvt_pk_bf16_f32 v145, v145, v145
    v_and_b32 v145, 0xffff0000, v145
    v_cvt_pk_bf16_f32 v146, v146, v146
    v_and_b32 v146, 0xffff0000, v146
    v_cvt_pk_bf16_f32 v147, v147, v147
    v_and_b32 v147, 0xffff0000, v147
    ds_write_b128 v30, v[144:147] offset:128
    s_mov_b64 exec, 1
    ds_write_b8 v0, v5 offset:56
    s_mov_b64 exec, -1
    v_and_b32 v128, 0xffffff00, v128
    v_and_b32 v129, 0xffffff00, v129
    v_and_b32 v130, 0xffffff00, v130
    v_and_b32 v131, 0xffffff00, v131
    v_and_b32 v132, 0xffffff00, v132
    v_and_b32 v133, 0xffffff00, v133
    v_and_b32 v134, 0xffffff00, v134
    v_and_b32 v135, 0xffffff00, v135
    v_and_b32 v136, 0xffffff00, v136
    v_and_b32 v137, 0xffffff00, v137
    v_and_b32 v138, 0xffffff00, v138
    v_and_b32 v139, 0xffffff00, v139
    v_and_b32 v140, 0xffffff00, v140
    v_and_b32 v141, 0xffffff00, v141
    v_and_b32 v142, 0xffffff00, v142
    v_and_b32 v143, 0xffffff00, v143
    v_pk_add_f32 v[128:129], v[128:129], v[132:133]
    v_pk_add_f32 v[130:131], v[130:131], v[134:135]
    v_pk_add_f32 v[136:137], v[136:137], v[140:141]
    v_pk_add_f32 v[138:139], v[138:139], v[142:143]
    v_pk_add_f32 v[128:129], v[128:129], v[136:137]
    v_pk_add_f32 v[130:131], v[130:131], v[138:139]
    v_cvt_pk_bf16_f32 v132, v128, v129
    v_cvt_pk_bf16_f32 v133, v130, v131
    v_lshlrev_b32 v128, 16, v132
    v_and_b32 v129, 0xffff0000, v132
    v_lshlrev_b32 v130, 16, v133
    v_and_b32 v131, 0xffff0000, v133
    v_add_f32 v128, v24, v128
    v_add_f32 v129, v24, v129
    v_add_f32 v130, v24, v130
    v_add_f32 v131, v24, v131
    v_cvt_pk_bf16_f32 v132, v128, v129
    v_cvt_pk_bf16_f32 v133, v130, v131
    ds_write_b64 v21, v[132:133]
    ds_read_b128 v[32:35], v18 offset:0
    ds_read_b128 v[36:39], v18 offset:32
    ds_read_b128 v[40:43], v18 offset:64
    ds_read_b128 v[44:47], v18 offset:96
    ds_read_b128 v[48:51], v18 offset:128
    ds_read_b128 v[52:55], v18 offset:160
    ds_read_b128 v[56:59], v18 offset:192
    ds_read_b128 v[60:63], v18 offset:224
    s_mov_b64 exec, 1
    ds_write_b8 v0, v5 offset:120
    s_mov_b64 exec, -1
    s_waitcnt vmcnt(6)
    s_add_u32 s10, s70, 88064
    s_add_u32 m0, s68, 8192
    s_nop 0
    buffer_load_dwordx4 v22, s[56:59], s10 offen lds
    s_waitcnt vmcnt(6)
    s_add_u32 s10, s70, 132096
    s_add_u32 m0, s68, 9216
    s_nop 0
    buffer_load_dwordx4 v13, s[56:59], s10 offen lds
    s_waitcnt vmcnt(6)
    s_add_u32 m0, s68, 10240
    s_nop 0
    buffer_load_dwordx4 v17, s[56:59], s10 offen lds
    s_waitcnt vmcnt(6)
    s_add_u32 m0, s68, 11264
    s_nop 0
    buffer_load_dwordx4 v22, s[56:59], s10 offen lds
    s_waitcnt vmcnt(6)
    s_add_u32 s10, s71, 176128
    s_add_u32 m0, s69, 12288
    s_nop 0
    buffer_load_dwordx4 v13, s[56:59], s10 offen lds
    s_waitcnt vmcnt(6)
    s_add_u32 m0, s69, 13312
    s_nop 0
    buffer_load_dwordx4 v17, s[56:59], s10 offen lds
    s_waitcnt vmcnt(6)
    s_add_u32 m0, s69, 14336
    s_nop 0
    buffer_load_dwordx4 v22, s[56:59], s10 offen lds
    s_waitcnt vmcnt(6)
    s_add_u32 s10, s71, 220160
    s_add_u32 m0, s69, 15360
    s_nop 0
    buffer_load_dwordx4 v13, s[56:59], s10 offen lds
    s_waitcnt vmcnt(6)
    s_add_u32 m0, s69, 16384
    s_nop 0
    buffer_load_dwordx4 v17, s[56:59], s10 offen lds
    s_waitcnt vmcnt(6)
    s_add_u32 m0, s69, 17408
    s_nop 0
    buffer_load_dwordx4 v22, s[56:59], s10 offen lds
    s_waitcnt vmcnt(6)
    s_add_u32 s10, s71, 264192
    s_add_u32 m0, s69, 18432
    s_nop 0
    buffer_load_dwordx4 v13, s[56:59], s10 offen lds
    s_waitcnt vmcnt(6)
    s_add_u32 m0, s69, 19456
    s_nop 0
    buffer_load_dwordx4 v17, s[56:59], s10 offen lds
    s_waitcnt vmcnt(6)
    s_add_u32 m0, s69, 20480
    s_nop 0
    buffer_load_dwordx4 v22, s[56:59], s10 offen lds
    s_waitcnt vmcnt(6)
    s_add_u32 s10, s71, 308224
    s_add_u32 m0, s69, 21504
    s_nop 0
    buffer_load_dwordx4 v13, s[56:59], s10 offen lds
    s_waitcnt vmcnt(6)
    s_add_u32 m0, s69, 22528
    s_nop 0
    buffer_load_dwordx4 v17, s[56:59], s10 offen lds
    s_waitcnt vmcnt(6)
    s_add_u32 m0, s69, 23552
    s_nop 0
    buffer_load_dwordx4 v22, s[56:59], s10 offen lds
    s_add_u32 s11, s99, 20480
    v_add_u32 v14, s11, v2
    s_add_u32 s11, s86, 118784
    v_add_u32 v15, s11, v2
    s_mul_i32 s10, s9, 24576
    s_add_u32 s10, s10, 20480
    v_bfe_u32 v8, v1, 2, 2
    v_lshl_add_u32 v8, v3, 3, v8
    v_mul_u32_u24 v8, 192, v8
    v_bfe_u32 v9, v1, 4, 1
    v_lshl_add_u32 v8, v9, 5, v8
    v_and_b32 v9, 1, v1
    v_lshl_add_u32 v8, v9, 4, v8
    v_bfe_u32 v9, v1, 1, 1
    v_lshl_add_u32 v8, v9, 3, v8
    v_add_u32 v16, s10, v8
    ds_read_b32 v6, v4 offset:104
    s_waitcnt lgkmcnt(0)
    v_cmp_eq_u32 vcc, s96, v6
    s_cbranch_vccnz F_140
F_139:
    ds_read_b32 v6, v4 offset:104
    s_add_u32 s84, s84, 1
    s_waitcnt lgkmcnt(0)
    v_cmp_ne_u32 vcc, s96, v6
    s_cmp_gt_u32 s84, 200000
    s_cbranch_scc1 F_140
    s_cbranch_vccnz F_139
F_140:
    s_waitcnt vmcnt(5)
    s_add_u32 s10, s65, 180224
    buffer_load_dwordx4 v[128:131], v12, s[60:63], s10 offen
    s_waitcnt vmcnt(5)
    s_add_u32 s10, s65, 196608
    buffer_load_dwordx4 v[132:135], v12, s[60:63], s10 offen
    s_waitcnt vmcnt(5)
    s_add_u32 s10, s65, 212992
    buffer_load_dwordx4 v[136:139], v12, s[60:63], s10 offen
    s_waitcnt vmcnt(5)
    s_add_u32 s10, s65, 229376
    buffer_load_dwordx4 v[140:143], v12, s[60:63], s10 offen
    s_waitcnt vmcnt(5)
    s_add_u32 s10, s65, 245760
    buffer_load_dwordx4 v[144:147], v12, s[60:63], s10 offen
    s_waitcnt vmcnt(5)
    s_add_u32 s10, s65, 262144
    buffer_load_dwordx4 v[148:151], v12, s[60:63], s10 offen
    s_waitcnt vmcnt(6)
    s_mov_b64 exec, 1
    ds_write_b8 v0, v5 offset:64
    s_mov_b64 exec, -1
    ds_read_b64_tr_b16 v[64:65], v16 offset:0
    ds_read_b64_tr_b16 v[66:67], v16 offset:768
    ds_read_b64_tr_b16 v[68:69], v16 offset:64
    ds_read_b64_tr_b16 v[70:71], v16 offset:832
    ds_read_b64_tr_b16 v[72:73], v16 offset:128
    ds_read_b64_tr_b16 v[74:75], v16 offset:896
    ds_read_b64_tr_b16 v[76:77], v16 offset:3072
    ds_read_b64_tr_b16 v[78:79], v16 offset:3840
    ds_read_b64_tr_b16 v[80:81], v16 offset:3136
    ds_read_b64_tr_b16 v[82:83], v16 offset:3904
    ds_read_b64_tr_b16 v[84:85], v16 offset:3200
    ds_read_b64_tr_b16 v[86:87], v16 offset:3968
    ds_read_b64_tr_b16 v[88:89], v16 offset:6144
    ds_read_b64_tr_b16 v[90:91], v16 offset:6912
    s_waitcnt lgkmcnt(12)
    v_mfma_f32_16x16x32_bf16 v[112:115], v[32:35], v[64:67], 0
    ds_read_b64_tr_b16 v[92:93], v16 offset:6208
    ds_read_b64_tr_b16 v[94:95], v16 offset:6976
    s_waitcnt lgkmcnt(12)
    v_mfma_f32_16x16x32_bf16 v[116:119], v[32:35], v[68:71], 0
    ds_read_b64_tr_b16 v[96:97], v16 offset:6272
    ds_read_b64_tr_b16 v[98:99], v16 offset:7040
    s_waitcnt lgkmcnt(12)
    v_mfma_f32_16x16x32_bf16 v[120:123], v[32:35], v[72:75], 0
    ds_read_b64_tr_b16 v[100:101], v16 offset:9216
    ds_read_b64_tr_b16 v[102:103], v16 offset:9984
    s_waitcnt lgkmcnt(12)
    v_mfma_f32_16x16x32_bf16 v[112:115], v[36:39], v[76:79], v[112:115]
    ds_read_b64_tr_b16 v[104:105], v16 offset:9280
    ds_read_b64_tr_b16 v[106:107], v16 offset:10048
    s_waitcnt lgkmcnt(12)
    v_mfma_f32_16x16x32_bf16 v[116:119], v[36:39], v[80:83], v[116:119]
    ds_read_b64_tr_b16 v[108:109], v16 offset:9344
    ds_read_b64_tr_b16 v[110:111], v16 offset:10112
    s_waitcnt lgkmcnt(12)
    v_mfma_f32_16x16x32_bf16 v[120:123], v[36:39], v[84:87], v[120:123]
    ds_read_b64_tr_b16 v[64:65], v16 offset:12288
    ds_read_b64_tr_b16 v[66:67], v16 offset:13056
    s_waitcnt lgkmcnt(12)
    v_mfma_f32_16x16x32_bf16 v[112:115], v[40:43], v[88:91], v[112:115]
    ds_read_b64_tr_b16 v[68:69], v16 offset:12352
    ds_read_b64_tr_b16 v[70:71], v16 offset:13120
    s_waitcnt lgkmcnt(12)
    v_mfma_f32_16x16x32_bf16 v[116:119], v[40:43], v[92:95], v[116:119]
    ds_read_b64_tr_b16 v[72:73], v16 offset:12416
    ds_read_b64_tr_b16 v[74:75], v16 offset:13184
    s_waitcnt lgkmcnt(12)
    v_mfma_f32_16x16x32_bf16 v[120:123], v[40:43], v[96:99], v[120:123]
    ds_read_b64_tr_b16 v[76:77], v16 offset:15360
    ds_read_b64_tr_b16 v[78:79], v16 offset:16128
    s_waitcnt lgkmcnt(12)
    v_mfma_f32_16x16x32_bf16 v[112:115], v[44:47], v[100:103], v[112:115]
    ds_read_b64_tr_b16 v[80:81], v16 offset:15424
    ds_read_b64_tr_b16 v[82:83], v16 offset:16192
    s_waitcnt lgkmcnt(12)
    v_mfma_f32_16x16x32_bf16 v[116:119], v[44:47], v[104:107], v[116:119]
    ds_read_b64_tr_b16 v[84:85], v16 offset:15488
    ds_read_b64_tr_b16 v[86:87], v16 offset:16256
    s_waitcnt lgkmcnt(12)
    v_mfma_f32_16x16x32_bf16 v[120:123], v[44:47], v[108:111], v[120:123]
    ds_read_b64_tr_b16 v[88:89], v16 offset:18432
    ds_read_b64_tr_b16 v[90:91], v16 offset:19200
    s_waitcnt lgkmcnt(12)
    v_mfma_f32_16x16x32_bf16 v[112:115], v[48:51], v[64:67], v[112:115]
    ds_read_b64_tr_b16 v[92:93], v16 offset:18496
    ds_read_b64_tr_b16 v[94:95], v16 offset:19264
    s_waitcnt lgkmcnt(12)
    v_mfma_f32_16x16x32_bf16 v[116:119], v[48:51], v[68:71], v[116:119]
    ds_read_b64_tr_b16 v[96:97], v16 offset:18560
    ds_read_b64_tr_b16 v[98:99], v16 offset:19328
    s_waitcnt lgkmcnt(12)
    v_mfma_f32_16x16x32_bf16 v[120:123], v[48:51], v[72:75], v[120:123]
    ds_read_b64_tr_b16 v[100:101], v16 offset:21504
    ds_read_b64_tr_b16 v[102:103], v16 offset:22272
    s_waitcnt lgkmcnt(12)
    v_mfma_f32_16x16x32_bf16 v[112:115], v[52:55], v[76:79], v[112:115]
    ds_read_b64_tr_b16 v[104:105], v16 offset:21568
    ds_read_b64_tr_b16 v[106:107], v16 offset:22336
    s_waitcnt lgkmcnt(12)
    v_mfma_f32_16x16x32_bf16 v[116:119], v[52:55], v[80:83], v[116:119]
    ds_read_b64_tr_b16 v[108:109], v16 offset:21632
    ds_read_b64_tr_b16 v[110:111], v16 offset:22400
    s_waitcnt lgkmcnt(12)
    v_mfma_f32_16x16x32_bf16 v[120:123], v[52:55], v[84:87], v[120:123]
    s_waitcnt lgkmcnt(10)
    v_mfma_f32_16x16x32_bf16 v[112:115], v[56:59], v[88:91], v[112:115]
    s_waitcnt lgkmcnt(8)
    v_mfma_f32_16x16x32_bf16 v[116:119], v[56:59], v[92:95], v[116:119]
    s_waitcnt lgkmcnt(6)
    v_mfma_f32_16x16x32_bf16 v[120:123], v[56:59], v[96:99], v[120:123]
    s_waitcnt lgkmcnt(4)
    v_mfma_f32_16x16x32_bf16 v[112:115], v[60:63], v[100:103], v[112:115]
    s_waitcnt lgkmcnt(2)
    v_mfma_f32_16x16x32_bf16 v[116:119], v[60:63], v[104:107], v[116:119]
    s_waitcnt lgkmcnt(0)
    v_mfma_f32_16x16x32_bf16 v[120:123], v[60:63], v[108:111], v[120:123]
    s_nop 3
    v_cvt_pk_bf16_f32 v8, v112, v114
    v_and_b32 v9, 0xffff0000, v8
    v_sub_f32 v9, v114, v9
    v_cvt_pk_bf16_f32 v9, v114, v9
    v_cvt_pk_bf16_f32 v10, v113, v115
    v_and_b32 v11, 0xffff0000, v10
    v_sub_f32 v11, v115, v11
    v_cvt_pk_bf16_f32 v11, v115, v11
    s_mov_b64 exec, 0xffff
    ds_write_b64 v19, v[8:9] offset:1024
    ds_write_b64 v19, v[10:11] offset:1280
    s_mov_b64 exec, -1
    v_cvt_pk_bf16_f32 v8, v116, v118
    v_and_b32 v9, 0xffff0000, v8
    v_sub_f32 v9, v118, v9
    v_cvt_pk_bf16_f32 v9, v118, v9
    v_cvt_pk_bf16_f32 v10, v117, v119
    v_and_b32 v11, 0xffff0000, v10
    v_sub_f32 v11, v119, v11
    v_cvt_pk_bf16_f32 v11, v119, v11
    s_mov_b64 exec, 0xffff
    ds_write_b64 v19, v[8:9] offset:2048
    ds_write_b64 v19, v[10:11] offset:2304
    s_mov_b64 exec, -1
    v_cvt_pk_bf16_f32 v8, v120, v122
    v_and_b32 v9, 0xffff0000, v8
    v_sub_f32 v9, v122, v9
    v_cvt_pk_bf16_f32 v9, v122, v9
    v_cvt_pk_bf16_f32 v10, v121, v123
    v_and_b32 v11, 0xffff0000, v10
    v_sub_f32 v11, v123, v11
    v_cvt_pk_bf16_f32 v11, v123, v11
    s_mov_b64 exec, 0xffff
    ds_write_b64 v19, v[8:9] offset:3072
    ds_write_b64 v19, v[10:11] offset:3328
    s_mov_b64 exec, -1
    s_mov_b64 exec, 1
    ds_write_b8 v0, v5 offset:68
    s_mov_b64 exec, -1
    s_waitcnt vmcnt(5)
    s_add_u32 s10, s65, 278528
    buffer_load_dwordx4 v[152:155], v12, s[60:63], s10 offen
    s_waitcnt vmcnt(5)
    s_add_u32 s10, s65, 294912
    buffer_load_dwordx4 v[156:159], v12, s[60:63], s10 offen
    s_waitcnt vmcnt(5)
    s_add_u32 s10, s65, 311296
    buffer_load_dwordx4 v[160:163], v12, s[60:63], s10 offen
    s_waitcnt vmcnt(5)
    s_add_u32 s10, s65, 327680
    buffer_load_dwordx4 v[164:167], v12, s[60:63], s10 offen
    s_waitcnt vmcnt(5)
    s_add_u32 s10, s66, 344064
    buffer_load_dwordx4 v[168:171], v12, s[60:63], s10 offen
    s_waitcnt vmcnt(0)
    s_waitcnt vmcnt(7)
    s_add_u32 s10, s64, 0
    s_add_u32 m0, s86, 118784
    s_nop 0
    buffer_load_dwordx4 v12, s[60:63], s10 offen lds
    s_waitcnt vmcnt(7)
    s_add_u32 s10, s64, 16384
    s_add_u32 m0, s86, 120832
    s_nop 0
    buffer_load_dwordx4 v12, s[60:63], s10 offen lds
    s_waitcnt vmcnt(7)
    s_add_u32 s10, s64, 32768
    s_add_u32 m0, s86, 122880
    s_nop 0
    buffer_load_dwordx4 v12, s[60:63], s10 offen lds
    s_waitcnt vmcnt(7)
    s_add_u32 s10, s64, 49152
    s_add_u32 m0, s86, 124928
    s_nop 0
    buffer_load_dwordx4 v12, s[60:63], s10 offen lds
    s_waitcnt vmcnt(7)
    s_add_u32 s10, s64, 65536
    s_add_u32 m0, s86, 126976
    s_nop 0
    buffer_load_dwordx4 v12, s[60:63], s10 offen lds
    s_waitcnt vmcnt(7)
    s_add_u32 s10, s64, 81920
    s_add_u32 m0, s86, 129024
    s_nop 0
    buffer_load_dwordx4 v12, s[60:63], s10 offen lds
    s_waitcnt vmcnt(7)
    s_add_u32 s10, s64, 98304
    s_add_u32 m0, s86, 131072
    s_nop 0
    buffer_load_dwordx4 v12, s[60:63], s10 offen lds
    s_waitcnt vmcnt(7)
    s_add_u32 s10, s64, 114688
    s_add_u32 m0, s86, 133120
    s_nop 0
    buffer_load_dwordx4 v12, s[60:63], s10 offen lds
    s_waitcnt vmcnt(7)
    s_add_u32 s10, s64, 131072
    s_add_u32 m0, s86, 135168
    s_nop 0
    buffer_load_dwordx4 v12, s[60:63], s10 offen lds
    s_waitcnt vmcnt(7)
    s_add_u32 s10, s64, 147456
    s_add_u32 m0, s86, 137216
    s_nop 0
    buffer_load_dwordx4 v12, s[60:63], s10 offen lds
    s_waitcnt vmcnt(7)
    s_add_u32 s10, s65, 163840
    s_add_u32 m0, s86, 139264
    s_nop 0
    buffer_load_dwordx4 v12, s[60:63], s10 offen lds
    s_waitcnt vmcnt(0)
    s_mov_b64 exec, 1
    ds_write_b8 v0, v5 offset:72
    s_mov_b64 exec, -1
    ds_read_b32 v6, v4 offset:116
    s_waitcnt lgkmcnt(0)
    v_cmp_eq_u32 vcc, s96, v6
    s_cbranch_vccnz F_142
F_141:
    ds_read_b32 v6, v4 offset:116
    s_add_u32 s84, s84, 1
    s_waitcnt lgkmcnt(0)
    v_cmp_ne_u32 vcc, s96, v6
    s_cmp_gt_u32 s84, 200000
    s_cbranch_scc1 F_142
    s_cbranch_vccnz F_141
F_142:
    s_mov_b64 exec, 134217727
    buffer_load_dword v31, v28, s[76:79], s83 offen
    s_mov_b64 exec, -1
    s_waitcnt vmcnt(7)
    s_add_u32 s10, s66, 360448
    buffer_load_dwordx4 v[172:175], v12, s[60:63], s10 offen
    s_waitcnt vmcnt(7)
    s_add_u32 s10, s66, 376832
    buffer_load_dwordx4 v[176:179], v12, s[60:63], s10 offen
    s_waitcnt vmcnt(7)
    s_add_u32 s10, s66, 393216
    buffer_load_dwordx4 v[180:183], v12, s[60:63], s10 offen
    s_waitcnt vmcnt(7)
    s_add_u32 s10, s66, 409600
    buffer_load_dwordx4 v[184:187], v12, s[60:63], s10 offen
    s_waitcnt vmcnt(7)
    s_add_u32 s10, s66, 425984
    buffer_load_dwordx4 v[188:191], v12, s[60:63], s10 offen
    s_waitcnt vmcnt(7)
    s_add_u32 s10, s66, 442368
    buffer_load_dwordx4 v[192:195], v12, s[60:63], s10 offen
    s_waitcnt vmcnt(7)
    s_add_u32 s10, s66, 458752
    buffer_load_dwordx4 v[196:199], v12, s[60:63], s10 offen
    s_waitcnt vmcnt(7)
    s_add_u32 s10, s66, 475136
    buffer_load_dwordx4 v[200:203], v12, s[60:63], s10 offen
    s_waitcnt vmcnt(7)
    s_add_u32 s10, s66, 491520
    buffer_load_dwordx4 v[204:207], v12, s[60:63], s10 offen
    s_waitcnt vmcnt(7)
    s_add_u32 s10, s66, 507904
    buffer_load_dwordx4 v[208:211], v12, s[60:63], s10 offen
    s_waitcnt vmcnt(7)
    s_add_u32 s10, s67, 524288
    buffer_load_dwordx4 v[212:215], v12, s[60:63], s10 offen
    s_waitcnt vmcnt(7)
    s_add_u32 s10, s67, 540672
    buffer_load_dwordx4 v[216:219], v12, s[60:63], s10 offen
    s_waitcnt vmcnt(7)
    s_add_u32 s10, s67, 557056
    buffer_load_dwordx4 v[220:223], v12, s[60:63], s10 offen
    s_waitcnt vmcnt(7)
    s_add_u32 s10, s67, 573440
    buffer_load_dwordx4 v[224:227], v12, s[60:63], s10 offen
    s_waitcnt vmcnt(7)
    s_add_u32 s10, s67, 589824
    buffer_load_dwordx4 v[228:231], v12, s[60:63], s10 offen
    s_waitcnt vmcnt(7)
    s_add_u32 s10, s67, 606208
    buffer_load_dwordx4 v[232:235], v12, s[60:63], s10 offen
    s_waitcnt vmcnt(7)
    s_add_u32 s10, s67, 622592
    buffer_load_dwordx4 v[236:239], v12, s[60:63], s10 offen
    s_waitcnt vmcnt(7)
    s_add_u32 s10, s67, 638976
    buffer_load_dwordx4 v[240:243], v12, s[60:63], s10 offen
    s_waitcnt vmcnt(7)
    s_add_u32 s10, s67, 655360
    buffer_load_dwordx4 v[244:247], v12, s[60:63], s10 offen
    s_waitcnt vmcnt(7)
    s_add_u32 s10, s67, 671744
    buffer_load_dwordx4 v[248:251], v12, s[60:63], s10 offen
    s_waitcnt vmcnt(7)
    s_add_u32 s10, s67, 688128
    buffer_load_dwordx4 v[252:255], v12, s[60:63], s10 offen
    ds_read_b32 v6, v4 offset:76
    s_waitcnt lgkmcnt(0)
    v_cmp_eq_u32 vcc, s96, v6
    s_cbranch_vccnz F_144
F_143:
    ds_read_b32 v6, v4 offset:76
    s_add_u32 s84, s84, 1
    s_waitcnt lgkmcnt(0)
    v_cmp_ne_u32 vcc, s96, v6
    s_cmp_gt_u32 s84, 200000
    s_cbranch_scc1 F_144
    s_cbranch_vccnz F_143
F_144:
    ds_write_b128 v14, v[128:131] offset:0
    ds_write_b128 v14, v[132:135] offset:2048
    ds_write_b128 v14, v[136:139] offset:4096
    ds_write_b128 v14, v[140:143] offset:6144
    ds_write_b128 v14, v[144:147] offset:8192
    ds_write_b128 v14, v[148:151] offset:10240
    ds_write_b128 v14, v[152:155] offset:12288
    ds_write_b128 v14, v[156:159] offset:14336
    ds_write_b128 v14, v[160:163] offset:16384
    ds_write_b128 v14, v[164:167] offset:18432
    ds_write_b128 v14, v[168:171] offset:20480
    s_waitcnt vmcnt(20)
    ds_write_b128 v14, v[172:175] offset:22528
    s_mov_b64 exec, 1
    ds_write_b8 v0, v5 offset:84
    s_mov_b64 exec, -1
    s_waitcnt vmcnt(19)
    ds_write_b128 v14, v[176:179] offset:24576
    s_waitcnt vmcnt(18)
    ds_write_b128 v14, v[180:183] offset:26624
    s_waitcnt vmcnt(17)
    ds_write_b128 v14, v[184:187] offset:28672
    s_waitcnt vmcnt(16)
    ds_write_b128 v14, v[188:191] offset:30720
    s_waitcnt vmcnt(15)
    ds_write_b128 v14, v[192:195] offset:32768
    s_waitcnt vmcnt(14)
    ds_write_b128 v14, v[196:199] offset:34816
    s_waitcnt vmcnt(13)
    ds_write_b128 v14, v[200:203] offset:36864
    s_waitcnt vmcnt(12)
    ds_write_b128 v14, v[204:207] offset:38912
    s_waitcnt vmcnt(11)
    ds_write_b128 v14, v[208:211] offset:40960
    s_waitcnt vmcnt(10)
    ds_write_b128 v14, v[212:215] offset:43008
    s_waitcnt vmcnt(9)
    ds_write_b128 v14, v[216:219] offset:45056
    s_waitcnt vmcnt(8)
    ds_write_b128 v14, v[220:223] offset:47104
    s_mov_b64 exec, 1
    ds_write_b8 v0, v5 offset:88
    s_mov_b64 exec, -1
    ds_read_b32 v6, v4 offset:80
    s_waitcnt lgkmcnt(0)
    v_cmp_eq_u32 vcc, s96, v6
    s_cbranch_vccnz F_146
F_145:
    ds_read_b32 v6, v4 offset:80
    s_add_u32 s84, s84, 1
    s_waitcnt lgkmcnt(0)
    v_cmp_ne_u32 vcc, s96, v6
    s_cmp_gt_u32 s84, 200000
    s_cbranch_scc1 F_146
    s_cbranch_vccnz F_145
F_146:
    s_waitcnt vmcnt(7)
    ds_write_b128 v15, v[224:227] offset:0
    s_waitcnt vmcnt(6)
    ds_write_b128 v15, v[228:231] offset:2048
    s_waitcnt vmcnt(5)
    ds_write_b128 v15, v[232:235] offset:4096
    s_waitcnt vmcnt(4)
    ds_write_b128 v15, v[236:239] offset:6144
    s_waitcnt vmcnt(3)
    ds_write_b128 v15, v[240:243] offset:8192
    s_waitcnt vmcnt(2)
    ds_write_b128 v15, v[244:247] offset:10240
    s_waitcnt vmcnt(1)
    ds_write_b128 v15, v[248:251] offset:12288
    s_waitcnt vmcnt(0)
    ds_write_b128 v15, v[252:255] offset:14336
    s_mov_b64 exec, 1
    ds_write_b8 v0, v5 offset:92
    s_mov_b64 exec, -1
    s_waitcnt lgkmcnt(0)
    s_endpgm
L_c3:
    s_and_b32 s70, s4, 7
    s_lshl_b32 s70, s70, 7
    s_add_u32 s70, s70, s85
    v_and_b32 v8, 31, v1
    v_bfe_u32 v9, v1, 1, 3
    v_xor_b32 v9, v9, v3
    v_lshlrev_b32 v8, 7, v8
    v_lshl_add_u32 v8, v9, 4, v8
    s_add_u32 s10, s86, 16384
    v_xor_b32 v36, 0, v8
    v_add_u32 v36, s10, v36
    v_xor_b32 v37, 32, v8
    v_add_u32 v37, s10, v37
    v_xor_b32 v38, 64, v8
    v_add_u32 v38, s10, v38
    v_xor_b32 v39, 96, v8
    v_add_u32 v39, s10, v39
    s_lshl_b32 s10, s3, 1
    s_lshr_b32 s12, s4, 3
    s_add_u32 s10, s10, s12
    s_lshl_b32 s10, s10, 1
    s_lshr_b32 s12, s5, 1
    s_add_u32 s87, s10, s12
    s_and_b32 s12, s4, 7
    s_lshl_b32 s12, s12, 1
    s_and_b32 s11, s5, 1
    s_add_u32 s99, s12, s11
    s_lshl_b32 s10, s87, 15
    s_lshl_b32 s13, s99, 6
    s_add_u32 s10, s10, s13
    v_and_b32 v8, 31, v1
    v_lshlrev_b32 v9, 10, v8
    v_lshl_add_u32 v40, v3, 4, v9
    v_add_u32 v40, s10, v40
    v_lshrrev_b32 v9, 2, v1
    v_lshrrev_b32 v10, 4, v1
    v_xor_b32 v10, v10, v1
    v_and_b32 v10, 3, v10
    v_lshlrev_b32 v10, 4, v10
    v_lshl_add_u32 v41, v9, 10, v10
    v_add_u32 v41, s10, v41
    v_add_u32 v42, 98304, v2
    v_mul_u32_u24 v44, 208, v8
    s_add_u32 s10, s86, 16384
    v_add_u32 v44, s10, v44
    v_and_b32 v45, 0x1f0, v2
    s_lshr_b32 s71, s85, 6
    s_add_u32 s71, s71, 65536
    s_bitcmp1_b32 s91, 4
    s_cbranch_scc1 L_6
    s_cmp_lg_u32 s97, 0
    s_cbranch_scc1 F_9
F_8:
    ds_read_b32 v6, v4 offset:112
    s_add_u32 s84, s84, 1
    s_waitcnt lgkmcnt(0)
    v_cmp_eq_u32 vcc, 0, v6
    s_cmp_gt_u32 s84, 200000
    s_cbranch_scc1 F_9
    s_cbranch_vccnz F_8
F_9:
    s_xor_b32 s10, s70, 0
    s_add_u32 m0, s86, 16384
    s_nop 0
    buffer_load_dwordx4 v34, s[40:43], s10 offen lds
    s_xor_b32 s10, s70, 8192
    s_add_u32 m0, s86, 17408
    s_nop 0
    buffer_load_dwordx4 v35, s[40:43], s10 offen lds
    s_xor_b32 s10, s70, 16384
    s_add_u32 m0, s86, 18432
    s_nop 0
    buffer_load_dwordx4 v34, s[40:43], s10 offen lds
    s_xor_b32 s10, s70, 24576
    s_add_u32 m0, s86, 19456
    s_nop 0
    buffer_load_dwordx4 v35, s[40:43], s10 offen lds
    s_xor_b32 s10, s70, 128
    s_add_u32 m0, s86, 20480
    s_nop 0
    buffer_load_dwordx4 v34, s[40:43], s10 offen lds
    s_xor_b32 s10, s70, 8320
    s_add_u32 m0, s86, 21504
    s_nop 0
    buffer_load_dwordx4 v35, s[40:43], s10 offen lds
    s_xor_b32 s10, s70, 16512
    s_add_u32 m0, s86, 22528
    s_nop 0
    buffer_load_dwordx4 v34, s[40:43], s10 offen lds
    s_xor_b32 s10, s70, 24704
    s_add_u32 m0, s86, 23552
    s_nop 0
    buffer_load_dwordx4 v35, s[40:43], s10 offen lds
    s_xor_b32 s10, s70, 256
    s_add_u32 m0, s86, 24576
    s_nop 0
    buffer_load_dwordx4 v34, s[40:43], s10 offen lds
    s_xor_b32 s10, s70, 8448
    s_add_u32 m0, s86, 25600
    s_nop 0
    buffer_load_dwordx4 v35, s[40:43], s10 offen lds
    s_xor_b32 s10, s70, 16640
    s_add_u32 m0, s86, 26624
    s_nop 0
    buffer_load_dwordx4 v34, s[40:43], s10 offen lds
    s_xor_b32 s10, s70, 24832
    s_add_u32 m0, s86, 27648
    s_nop 0
    buffer_load_dwordx4 v35, s[40:43], s10 offen lds
    s_mov_b64 exec, 1
    ds_write_b8 v0, v5 offset:124
    s_mov_b64 exec, -1
L_6:
    s_barrier
    s_setprio 2
    s_bitcmp0_b32 s91, 4
    s_cbranch_scc1 L_7
    s_xor_b32 s10, s70, 0
    s_add_u32 m0, s86, 16384
    s_nop 0
    buffer_load_dwordx4 v34, s[40:43], s10 offen lds
    s_xor_b32 s10, s70, 8192
    s_add_u32 m0, s86, 17408
    s_nop 0
    buffer_load_dwordx4 v35, s[40:43], s10 offen lds
    s_xor_b32 s10, s70, 16384
    s_add_u32 m0, s86, 18432
    s_nop 0
    buffer_load_dwordx4 v34, s[40:43], s10 offen lds
    s_xor_b32 s10, s70, 24576
    s_add_u32 m0, s86, 19456
    s_nop 0
    buffer_load_dwordx4 v35, s[40:43], s10 offen lds
    s_xor_b32 s10, s70, 128
    s_add_u32 m0, s86, 20480
    s_nop 0
    buffer_load_dwordx4 v34, s[40:43], s10 offen lds
    s_xor_b32 s10, s70, 8320
    s_add_u32 m0, s86, 21504
    s_nop 0
    buffer_load_dwordx4 v35, s[40:43], s10 offen lds
    s_xor_b32 s10, s70, 16512
    s_add_u32 m0, s86, 22528
    s_nop 0
    buffer_load_dwordx4 v34, s[40:43], s10 offen lds
    s_xor_b32 s10, s70, 24704
    s_add_u32 m0, s86, 23552
    s_nop 0
    buffer_load_dwordx4 v35, s[40:43], s10 offen lds
    s_xor_b32 s10, s70, 256
    s_add_u32 m0, s86, 24576
    s_nop 0
    buffer_load_dwordx4 v34, s[40:43], s10 offen lds
    s_xor_b32 s10, s70, 8448
    s_add_u32 m0, s86, 25600
    s_nop 0
    buffer_load_dwordx4 v35, s[40:43], s10 offen lds
    s_xor_b32 s10, s70, 16640
    s_add_u32 m0, s86, 26624
    s_nop 0
    buffer_load_dwordx4 v34, s[40:43], s10 offen lds
    s_xor_b32 s10, s70, 24832
    s_add_u32 m0, s86, 27648
    s_nop 0
    buffer_load_dwordx4 v35, s[40:43], s10 offen lds
L_7:
    s_xor_b32 s10, s70, 384
    s_add_u32 m0, s86, 28672
    s_nop 0
    buffer_load_dwordx4 v34, s[40:43], s10 offen lds
    s_xor_b32 s10, s70, 8576
    s_add_u32 m0, s86, 29696
    s_nop 0
    buffer_load_dwordx4 v35, s[40:43], s10 offen lds
    s_xor_b32 s10, s70, 16768
    s_add_u32 m0, s86, 30720
    s_nop 0
    buffer_load_dwordx4 v34, s[40:43], s10 offen lds
    s_xor_b32 s10, s70, 24960
    s_add_u32 m0, s86, 31744
    s_nop 0
    buffer_load_dwordx4 v35, s[40:43], s10 offen lds
    s_xor_b32 s10, s70, 512
    s_add_u32 m0, s86, 32768
    s_nop 0
    buffer_load_dwordx4 v34, s[40:43], s10 offen lds
    s_xor_b32 s10, s70, 8704
    s_add_u32 m0, s86, 33792
    s_nop 0
    buffer_load_dwordx4 v35, s[40:43], s10 offen lds
    s_xor_b32 s10, s70, 16896
    s_add_u32 m0, s86, 34816
    s_nop 0
    buffer_load_dwordx4 v34, s[40:43], s10 offen lds
    s_xor_b32 s10, s70, 25088
    s_add_u32 m0, s86, 35840
    s_nop 0
    buffer_load_dwordx4 v35, s[40:43], s10 offen lds
    s_waitcnt vmcnt(16)
    ds_read_b128 v[128:131], v36 offset:0
    ds_read_b128 v[132:135], v37 offset:0
    ds_read_b128 v[136:139], v38 offset:0
    ds_read_b128 v[140:143], v39 offset:0
    s_waitcnt lgkmcnt(0)
    s_xor_b32 s10, s70, 640
    s_add_u32 m0, s86, 16384
    s_nop 0
    buffer_load_dwordx4 v34, s[40:43], s10 offen lds
    s_xor_b32 s10, s70, 8832
    s_add_u32 m0, s86, 17408
    s_nop 0
    buffer_load_dwordx4 v35, s[40:43], s10 offen lds
    s_xor_b32 s10, s70, 17024
    s_add_u32 m0, s86, 18432
    s_nop 0
    buffer_load_dwordx4 v34, s[40:43], s10 offen lds
    s_xor_b32 s10, s70, 25216
    s_add_u32 m0, s86, 19456
    s_nop 0
    buffer_load_dwordx4 v35, s[40:43], s10 offen lds
    s_waitcnt vmcnt(16)
    ds_read_b128 v[144:147], v36 offset:4096
    ds_read_b128 v[148:151], v37 offset:4096
    ds_read_b128 v[152:155], v38 offset:4096
    ds_read_b128 v[156:159], v39 offset:4096
    s_waitcnt lgkmcnt(0)
    s_xor_b32 s10, s70, 768
    s_add_u32 m0, s86, 20480
    s_nop 0
    buffer_load_dwordx4 v34, s[40:43], s10 offen lds
    s_xor_b32 s10, s70, 8960
    s_add_u32 m0, s86, 21504
    s_nop 0
    buffer_load_dwordx4 v35, s[40:43], s10 offen lds
    s_xor_b32 s10, s70, 17152
    s_add_u32 m0, s86, 22528
    s_nop 0
    buffer_load_dwordx4 v34, s[40:43], s10 offen lds
    s_xor_b32 s10, s70, 25344
    s_add_u32 m0, s86, 23552
    s_nop 0
    buffer_load_dwordx4 v35, s[40:43], s10 offen lds
    s_waitcnt vmcnt(16)
    ds_read_b128 v[160:163], v36 offset:8192
    ds_read_b128 v[164:167], v37 offset:8192
    ds_read_b128 v[168:171], v38 offset:8192
    ds_read_b128 v[172:175], v39 offset:8192
    s_waitcnt lgkmcnt(0)
    s_xor_b32 s10, s70, 896
    s_add_u32 m0, s86, 24576
    s_nop 0
    buffer_load_dwordx4 v34, s[40:43], s10 offen lds
    s_xor_b32 s10, s70, 9088
    s_add_u32 m0, s86, 25600
    s_nop 0
    buffer_load_dwordx4 v35, s[40:43], s10 offen lds
    s_xor_b32 s10, s70, 17280
    s_add_u32 m0, s86, 26624
    s_nop 0
    buffer_load_dwordx4 v34, s[40:43], s10 offen lds
    s_xor_b32 s10, s70, 25472
    s_add_u32 m0, s86, 27648
    s_nop 0
    buffer_load_dwordx4 v35, s[40:43], s10 offen lds
    buffer_load_dwordx4 v[48:51], v45, s[76:79], s71 offen sc1
    s_bitcmp1_b32 s91, 4
    s_cselect_b64 exec, 1, -1
    s_cselect_b32 s10, 0, 2048
    v_add_u32 v32, s10, v32
    global_load_dword v33, v32, s[44:45]
    s_mov_b64 exec, -1
    s_waitcnt vmcnt(18)
    ds_read_b128 v[176:179], v36 offset:12288
    ds_read_b128 v[180:183], v37 offset:12288
    ds_read_b128 v[184:187], v38 offset:12288
    ds_read_b128 v[188:191], v39 offset:12288
    s_waitcnt vmcnt(14)
    ds_read_b128 v[192:195], v36 offset:16384
    ds_read_b128 v[196:199], v37 offset:16384
    ds_read_b128 v[200:203], v38 offset:16384
    ds_read_b128 v[204:207], v39 offset:16384
    s_mov_b64 exec, 1
    ds_write_b8 v0, v5 offset:4
    s_mov_b64 exec, -1
    ds_read_b32 v6, v4 offset:8
    s_waitcnt lgkmcnt(0)
    v_cmp_eq_u32 vcc, s96, v6
    s_cbranch_vccnz F_11
F_10:
    ds_read_b32 v6, v4 offset:8
    s_add_u32 s84, s84, 1
    s_waitcnt lgkmcnt(0)
    v_cmp_ne_u32 vcc, s96, v6
    s_cmp_gt_u32 s84, 200000
    s_cbranch_scc1 F_11
    s_cbranch_vccnz F_10
F_11:
    ds_read_b128 v[8:11], v42 offset:0
    ds_read_b128 v[12:15], v42 offset:1024
    ds_read_b128 v[16:19], v42 offset:2048
    ds_read_b128 v[20:23], v42 offset:3072
    s_waitcnt lgkmcnt(3)
    v_mfma_f32_32x32x16_bf16 v[56:71], v[8:11], v[128:131], 0
    ds_read_b128 v[8:11], v42 offset:4096
    s_waitcnt lgkmcnt(3)
    v_mfma_f32_32x32x16_bf16 v[56:71], v[12:15], v[132:135], v[56:71]
    ds_read_b128 v[12:15], v42 offset:5120
    s_waitcnt lgkmcnt(3)
    v_mfma_f32_32x32x16_bf16 v[56:71], v[16:19], v[136:139], v[56:71]
    ds_read_b128 v[16:19], v42 offset:6144
    s_waitcnt lgkmcnt(3)
    v_mfma_f32_32x32x16_bf16 v[56:71], v[20:23], v[140:143], v[56:71]
    ds_read_b128 v[20:23], v42 offset:7168
    s_waitcnt lgkmcnt(3)
    v_mfma_f32_32x32x16_bf16 v[56:71], v[8:11], v[144:147], v[56:71]
    ds_read_b128 v[8:11], v42 offset:8192
    s_waitcnt lgkmcnt(3)
    v_mfma_f32_32x32x16_bf16 v[56:71], v[12:15], v[148:151], v[56:71]
    ds_read_b128 v[12:15], v42 offset:9216
    s_waitcnt lgkmcnt(3)
    v_mfma_f32_32x32x16_bf16 v[56:71], v[16:19], v[152:155], v[56:71]
    ds_read_b128 v[16:19], v42 offset:10240
    s_waitcnt lgkmcnt(3)
    v_mfma_f32_32x32x16_bf16 v[56:71], v[20:23], v[156:159], v[56:71]
    ds_read_b128 v[20:23], v42 offset:11264
    s_waitcnt lgkmcnt(3)
    v_mfma_f32_32x32x16_bf16 v[56:71], v[8:11], v[160:163], v[56:71]
    ds_read_b128 v[8:11], v42 offset:12288
    s_waitcnt lgkmcnt(3)
    v_mfma_f32_32x32x16_bf16 v[56:71], v[12:15], v[164:167], v[56:71]
    ds_read_b128 v[12:15], v42 offset:13312
    s_waitcnt lgkmcnt(3)
    v_mfma_f32_32x32x16_bf16 v[56:71], v[16:19], v[168:171], v[56:71]
    ds_read_b128 v[16:19], v42 offset:14336
    s_waitcnt lgkmcnt(3)
    v_mfma_f32_32x32x16_bf16 v[56:71], v[20:23], v[172:175], v[56:71]
    ds_read_b128 v[20:23], v42 offset:15360
    s_waitcnt lgkmcnt(3)
    v_mfma_f32_32x32x16_bf16 v[56:71], v[8:11], v[176:179], v[56:71]
    ds_read_b128 v[8:11], v42 offset:16384
    s_waitcnt vmcnt(10)
    ds_read_b128 v[208:211], v36 offset:0
    ds_read_b128 v[212:215], v37 offset:0
    ds_read_b128 v[216:219], v38 offset:0
    ds_read_b128 v[220:223], v39 offset:0
    s_waitcnt lgkmcnt(7)
    v_mfma_f32_32x32x16_bf16 v[56:71], v[12:15], v[180:183], v[56:71]
    ds_read_b128 v[12:15], v42 offset:17408
    s_waitcnt lgkmcnt(7)
    v_mfma_f32_32x32x16_bf16 v[56:71], v[16:19], v[184:187], v[56:71]
    ds_read_b128 v[16:19], v42 offset:18432
    s_waitcnt lgkmcnt(7)
    v_mfma_f32_32x32x16_bf16 v[56:71], v[20:23], v[188:191], v[56:71]
    ds_read_b128 v[20:23], v42 offset:19456
    s_waitcnt lgkmcnt(7)
    v_mfma_f32_32x32x16_bf16 v[56:71], v[8:11], v[192:195], v[56:71]
    ds_read_b128 v[8:11], v42 offset:20480
    s_waitcnt vmcnt(6)
    ds_read_b128 v[224:227], v36 offset:4096
    ds_read_b128 v[228:231], v37 offset:4096
    ds_read_b128 v[232:235], v38 offset:4096
    ds_read_b128 v[236:239], v39 offset:4096
    s_waitcnt lgkmcnt(7)
    v_mfma_f32_32x32x16_bf16 v[56:71], v[12:15], v[196:199], v[56:71]
    ds_read_b128 v[12:15], v42 offset:21504
    s_waitcnt lgkmcnt(7)
    v_mfma_f32_32x32x16_bf16 v[56:71], v[16:19], v[200:203], v[56:71]
    ds_read_b128 v[16:19], v42 offset:22528
    s_waitcnt lgkmcnt(7)
    v_mfma_f32_32x32x16_bf16 v[56:71], v[20:23], v[204:207], v[56:71]
    ds_read_b128 v[20:23], v42 offset:23552
    s_waitcnt lgkmcnt(7)
    v_mfma_f32_32x32x16_bf16 v[56:71], v[8:11], v[208:211], v[56:71]
    ds_read_b128 v[8:11], v42 offset:24576
    s_waitcnt vmcnt(2)
    ds_read_b128 v[240:243], v36 offset:8192
    ds_read_b128 v[244:247], v37 offset:8192
    ds_read_b128 v[248:251], v38 offset:8192
    ds_read_b128 v[252:255], v39 offset:8192
    s_waitcnt lgkmcnt(7)
    v_mfma_f32_32x32x16_bf16 v[56:71], v[12:15], v[212:215], v[56:71]
    ds_read_b128 v[12:15], v42 offset:25600
    s_waitcnt vmcnt(1)
    v_xor_b32 v52, s6, v49
    v_xor_b32 v53, s6, v51
    v_or_b32 v52, v52, v53
    v_cmp_ne_u32 vcc, 0, v52
    s_cbranch_vccz S_15
S_14:
    buffer_load_dwordx4 v[48:51], v45, s[76:79], s71 offen sc1
    s_add_u32 s84, s84, 8
    s_waitcnt vmcnt(0)
    v_xor_b32 v52, s6, v49
    v_xor_b32 v53, s6, v51
    v_or_b32 v52, v52, v53
    v_cmp_ne_u32 vcc, 0, v52
    s_cmp_gt_u32 s84, 200000
    s_cbranch_scc1 S_15
    s_cbranch_vccnz S_14
S_15:
    s_waitcnt lgkmcnt(7)
    v_mfma_f32_32x32x16_bf16 v[56:71], v[16:19], v[216:219], v[56:71]
    ds_read_b128 v[16:19], v42 offset:26624
    s_waitcnt lgkmcnt(7)
    v_mfma_f32_32x32x16_bf16 v[56:71], v[20:23], v[220:223], v[56:71]
    ds_read_b128 v[20:23], v42 offset:27648
    s_waitcnt lgkmcnt(3)
    s_movk_i32 s11, 0x4000
    s_add_u32 m0, s86, 24576
    s_nop 0
    buffer_load_dwordx4 v41, s[40:43], 0 offen lds
    s_add_u32 m0, s86, 25600
    s_nop 0
    buffer_load_dwordx4 v41, s[40:43], s11 offen lds
    v_mfma_f32_32x32x16_bf16 v[56:71], v[8:11], v[224:227], v[56:71]
    ds_read_b128 v[8:11], v42 offset:28672
    v_mul_f32 v48, 0xbb000000, v48
    v_mul_f32 v49, v48, v48
    v_mov_b32 v51, 0x3b000000
    s_waitcnt lgkmcnt(3)
    v_mfma_f32_32x32x16_bf16 v[56:71], v[12:15], v[228:231], v[56:71]
    ds_read_b128 v[12:15], v42 offset:29696
    ds_read_b32 v7, v4 offset:12
    v_fma_f32 v50, v50, v51, -v49
    v_max_f32 v50, 0, v50
    v_add_f32 v50, 0x3727c5ac, v50
    s_waitcnt lgkmcnt(4)
    v_mfma_f32_32x32x16_bf16 v[56:71], v[16:19], v[232:235], v[56:71]
    ds_read_b128 v[16:19], v42 offset:30720
    v_rsq_f32 v46, v50
    s_nop 0
    v_mul_f32 v50, v50, v46
    v_cvt_pk_bf16_f32 v53, v50, v50
    s_waitcnt lgkmcnt(4)
    v_mfma_f32_32x32x16_bf16 v[56:71], v[20:23], v[236:239], v[56:71]
    ds_read_b128 v[20:23], v42 offset:31744
    v_and_b32 v49, 0xffff0000, v53
    v_sub_f32 v49, v50, v49
    v_cvt_pk_bf16_f32 v52, v48, v49
    s_waitcnt lgkmcnt(4)
    v_mfma_f32_32x32x16_bf16 v[56:71], v[8:11], v[240:243], v[56:71]
    s_waitcnt lgkmcnt(2)
    v_cmp_eq_u32 vcc, s96, v7
    s_cbranch_vccnz F_13
F_12:
    ds_read_b32 v7, v4 offset:12
    s_add_u32 s84, s84, 1
    s_waitcnt lgkmcnt(0)
    v_cmp_ne_u32 vcc, s96, v7
    s_cmp_gt_u32 s84, 200000
    s_cbranch_scc1 F_13
    s_cbranch_vccnz F_12
F_13:
    ds_read_b128 v[8:11], v2 offset:8192
    v_mov_b32 v55, v53
    v_mov_b32 v54, v52
    v_mul_f32 v47, s81, v46
    v_mfma_f32_32x32x16_bf16 v[56:71], v[12:15], v[244:247], v[56:71]
    s_waitcnt lgkmcnt(2)
    v_mfma_f32_32x32x16_bf16 v[56:71], v[16:19], v[248:251], v[56:71]
    s_waitcnt lgkmcnt(1)
    v_mfma_f32_32x32x16_bf16 v[56:71], v[20:23], v[252:255], v[56:71]
    s_waitcnt lgkmcnt(0)
    v_mfma_f32_32x32x16_bf16 v[56:71], v[8:11], v[52:55], v[56:71]
    s_mov_b64 exec, 1
    ds_write_b8 v0, v5 offset:28
    s_mov_b64 exec, -1
    s_nop 8
    v_max3_f32 v32, v56, v57, v58
    v_min3_f32 v34, v56, v57, v58
    v_max3_f32 v32, v32, v59, v60
    v_min3_f32 v34, v34, v59, v60
    v_max3_f32 v32, v32, v61, v62
    v_min3_f32 v34, v34, v61, v62
    v_max3_f32 v32, v32, v63, v64
    v_min3_f32 v34, v34, v63, v64
    v_max3_f32 v32, v32, v65, v66
    v_min3_f32 v34, v34, v65, v66
    v_max3_f32 v32, v32, v67, v68
    v_min3_f32 v34, v34, v67, v68
    v_max3_f32 v32, v32, v69, v70
    v_min3_f32 v34, v34, v69, v70
    v_max_f32 v32, v32, v71
    v_min_f32 v34, v34, v71
    v_mul_f32 v32, v47, v32
    v_mul_f32 v34, v47, v34
    v_fma_f32 v104, v56, v47, -v32
    v_fma_f32 v56, -v56, v47, v34
    v_exp_f32 v104, v104
    v_exp_f32 v56, v56
    v_fma_f32 v105, v57, v47, -v32
    v_fma_f32 v57, -v57, v47, v34
    v_exp_f32 v105, v105
    v_exp_f32 v57, v57
    v_fma_f32 v106, v58, v47, -v32
    v_fma_f32 v58, -v58, v47, v34
    v_exp_f32 v106, v106
    v_exp_f32 v58, v58
    v_add_f32 v35, v104, v105
    v_add_f32 v36, v56, v57
    v_fma_f32 v107, v59, v47, -v32
    v_fma_f32 v59, -v59, v47, v34
    v_exp_f32 v107, v107
    v_exp_f32 v59, v59
    v_add_f32 v35, v35, v106
    v_add_f32 v36, v36, v58
    v_fma_f32 v108, v60, v47, -v32
    v_fma_f32 v60, -v60, v47, v34
    v_exp_f32 v108, v108
    v_exp_f32 v60, v60
    v_add_f32 v35, v35, v107
    v_add_f32 v36, v36, v59
    v_fma_f32 v109, v61, v47, -v32
    v_fma_f32 v61, -v61, v47, v34
    v_exp_f32 v109, v109
    v_exp_f32 v61, v61
    v_add_f32 v35, v35, v108
    v_add_f32 v36, v36, v60
    v_fma_f32 v110, v62, v47, -v32
    v_fma_f32 v62, -v62, v47, v34
    v_exp_f32 v110, v110
    v_exp_f32 v62, v62
    v_add_f32 v35, v35, v109
    v_add_f32 v36, v36, v61
    v_fma_f32 v111, v63, v47, -v32
    v_fma_f32 v63, -v63, v47, v34
    v_exp_f32 v111, v111
    v_exp_f32 v63, v63
    v_add_f32 v35, v35, v110
    v_add_f32 v36, v36, v62
    v_fma_f32 v112, v64, v47, -v32
    v_fma_f32 v64, -v64, v47, v34
    v_exp_f32 v112, v112
    v_exp_f32 v64, v64
    v_add_f32 v35, v35, v111
    v_add_f32 v36, v36, v63
    v_fma_f32 v113, v65, v47, -v32
    v_fma_f32 v65, -v65, v47, v34
    v_exp_f32 v113, v113
    v_exp_f32 v65, v65
    v_add_f32 v35, v35, v112
    v_add_f32 v36, v36, v64
    v_fma_f32 v114, v66, v47, -v32
    v_fma_f32 v66, -v66, v47, v34
    v_exp_f32 v114, v114
    v_exp_f32 v66, v66
    v_add_f32 v35, v35, v113
    v_add_f32 v36, v36, v65
    v_fma_f32 v115, v67, v47, -v32
    v_fma_f32 v67, -v67, v47, v34
    ds_read_b32 v6, v4 offset:16
    v_exp_f32 v115, v115
    v_exp_f32 v67, v67
    v_add_f32 v35, v35, v114
    v_add_f32 v36, v36, v66
    v_fma_f32 v116, v68, v47, -v32
    v_fma_f32 v68, -v68, v47, v34
    v_exp_f32 v116, v116
    v_exp_f32 v68, v68
    s_waitcnt lgkmcnt(0)
    v_cmp_eq_u32 vcc, s96, v6
    s_cbranch_vccnz F_19
F_18:
    ds_read_b32 v6, v4 offset:16
    s_add_u32 s84, s84, 1
    s_waitcnt lgkmcnt(0)
    v_cmp_ne_u32 vcc, s96, v6
    s_cmp_gt_u32 s84, 200000
    s_cbranch_scc1 F_19
    s_cbranch_vccnz F_18
F_19:
    ds_read_b128 v[8:11], v42 offset:32768
    ds_read_b128 v[12:15], v42 offset:33792
    ds_read_b128 v[16:19], v42 offset:34816
    ds_read_b128 v[20:23], v42 offset:35840
    v_add_f32 v35, v35, v115
    v_add_f32 v36, v36, v67
    s_waitcnt lgkmcnt(3)
    v_mfma_f32_32x32x16_bf16 v[72:87], v[8:11], v[128:131], 0
    ds_read_b128 v[8:11], v42 offset:36864
    v_fma_f32 v117, v69, v47, -v32
    v_fma_f32 v69, -v69, v47, v34
    v_exp_f32 v117, v117
    s_waitcnt lgkmcnt(3)
    v_mfma_f32_32x32x16_bf16 v[72:87], v[12:15], v[132:135], v[72:87]
    ds_read_b128 v[12:15], v42 offset:37888
    v_exp_f32 v69, v69
    v_add_f32 v35, v35, v116
    v_add_f32 v36, v36, v68
    s_waitcnt lgkmcnt(3)
    v_mfma_f32_32x32x16_bf16 v[72:87], v[16:19], v[136:139], v[72:87]
    ds_read_b128 v[16:19], v42 offset:38912
    v_fma_f32 v118, v70, v47, -v32
    v_fma_f32 v70, -v70, v47, v34
    v_exp_f32 v118, v118
    s_waitcnt lgkmcnt(3)
    v_mfma_f32_32x32x16_bf16 v[72:87], v[20:23], v[140:143], v[72:87]
    ds_read_b128 v[20:23], v42 offset:39936
    v_exp_f32 v70, v70
    v_add_f32 v35, v35, v117
    v_add_f32 v36, v36, v69
    s_waitcnt lgkmcnt(3)
    v_mfma_f32_32x32x16_bf16 v[72:87], v[8:11], v[144:147], v[72:87]
    ds_read_b128 v[8:11], v42 offset:40960
    v_fma_f32 v119, v71, v47, -v32
    v_fma_f32 v71, -v71, v47, v34
    v_exp_f32 v119, v119
    s_waitcnt lgkmcnt(3)
    v_mfma_f32_32x32x16_bf16 v[72:87], v[12:15], v[148:151], v[72:87]
    ds_read_b128 v[12:15], v42 offset:41984
    v_exp_f32 v71, v71
    v_add_f32 v35, v35, v118
    v_add_f32 v36, v36, v70
    s_waitcnt lgkmcnt(3)
    v_mfma_f32_32x32x16_bf16 v[72:87], v[16:19], v[152:155], v[72:87]
    ds_read_b128 v[16:19], v42 offset:43008
    v_add_f32 v35, v35, v119
    v_add_f32 v36, v36, v71
    v_rcp_f32 v35, v35
    s_waitcnt lgkmcnt(3)
    v_mfma_f32_32x32x16_bf16 v[72:87], v[20:23], v[156:159], v[72:87]
    ds_read_b128 v[20:23], v42 offset:44032
    v_rcp_f32 v36, v36
    v_mul_f32 v104, v35, v104
    v_mul_f32 v105, v35, v105
    s_waitcnt lgkmcnt(3)
    v_mfma_f32_32x32x16_bf16 v[72:87], v[8:11], v[160:163], v[72:87]
    ds_read_b128 v[8:11], v42 offset:45056
    v_cvt_pk_bf16_f32 v88, v104, v105
    v_mul_f32 v106, v35, v106
    v_mul_f32 v107, v35, v107
    s_waitcnt lgkmcnt(3)
    v_mfma_f32_32x32x16_bf16 v[72:87], v[12:15], v[164:167], v[72:87]
    ds_read_b128 v[12:15], v42 offset:46080
    v_cvt_pk_bf16_f32 v89, v106, v107
    v_mul_f32 v108, v35, v108
    v_mul_f32 v109, v35, v109
    s_waitcnt lgkmcnt(3)
    v_mfma_f32_32x32x16_bf16 v[72:87], v[16:19], v[168:171], v[72:87]
    ds_read_b128 v[16:19], v42 offset:47104
    v_cvt_pk_bf16_f32 v90, v108, v109
    v_mul_f32 v110, v35, v110
    v_mul_f32 v111, v35, v111
    s_waitcnt lgkmcnt(3)
    v_mfma_f32_32x32x16_bf16 v[72:87], v[20:23], v[172:175], v[72:87]
    ds_read_b128 v[20:23], v42 offset:48128
    v_cvt_pk_bf16_f32 v91, v110, v111
    v_mul_f32 v112, v35, v112
    v_mul_f32 v113, v35, v113
    s_waitcnt lgkmcnt(3)
    v_mfma_f32_32x32x16_bf16 v[72:87], v[8:11], v[176:179], v[72:87]
    ds_read_b128 v[8:11], v42 offset:49152
    v_cvt_pk_bf16_f32 v92, v112, v113
    v_mul_f32 v114, v35, v114
    v_mul_f32 v115, v35, v115
    s_waitcnt lgkmcnt(3)
    v_mfma_f32_32x32x16_bf16 v[72:87], v[12:15], v[180:183], v[72:87]
    ds_read_b128 v[12:15], v42 offset:50176
    v_cvt_pk_bf16_f32 v93, v114, v115
    v_mul_f32 v116, v35, v116
    v_mul_f32 v117, v35, v117
    s_waitcnt lgkmcnt(3)
    v_mfma_f32_32x32x16_bf16 v[72:87], v[16:19], v[184:187], v[72:87]
    ds_read_b128 v[16:19], v42 offset:51200
    v_cvt_pk_bf16_f32 v94, v116, v117
    v_mul_f32 v118, v35, v118
    v_mul_f32 v119, v35, v119
    s_waitcnt lgkmcnt(3)
    v_mfma_f32_32x32x16_bf16 v[72:87], v[20:23], v[188:191], v[72:87]
    ds_read_b128 v[20:23], v42 offset:52224
    v_cvt_pk_bf16_f32 v95, v118, v119
    v_mul_f32 v56, v36, v56
    v_mul_f32 v57, v36, v57
    s_waitcnt lgkmcnt(3)
    v_mfma_f32_32x32x16_bf16 v[72:87], v[8:11], v[192:195], v[72:87]
    ds_read_b128 v[8:11], v42 offset:53248
    v_cvt_pk_bf16_f32 v96, v56, v57
    v_mul_f32 v58, v36, v58
    v_mul_f32 v59, v36, v59
    s_waitcnt lgkmcnt(3)
    v_mfma_f32_32x32x16_bf16 v[72:87], v[12:15], v[196:199], v[72:87]
    ds_read_b128 v[12:15], v42 offset:54272
    v_cvt_pk_bf16_f32 v97, v58, v59
    v_mul_f32 v60, v36, v60
    v_mul_f32 v61, v36, v61
    s_waitcnt lgkmcnt(3)
    v_mfma_f32_32x32x16_bf16 v[72:87], v[16:19], v[200:203], v[72:87]
    ds_read_b128 v[16:19], v42 offset:55296
    v_cvt_pk_bf16_f32 v98, v60, v61
    v_mul_f32 v62, v36, v62
    v_mul_f32 v63, v36, v63
    s_waitcnt lgkmcnt(3)
    v_mfma_f32_32x32x16_bf16 v[72:87], v[20:23], v[204:207], v[72:87]
    ds_read_b128 v[20:23], v42 offset:56320
    v_cvt_pk_bf16_f32 v99, v62, v63
    v_mul_f32 v64, v36, v64
    v_mul_f32 v65, v36, v65
    s_waitcnt lgkmcnt(3)
    v_mfma_f32_32x32x16_bf16 v[72:87], v[8:11], v[208:211], v[72:87]
    ds_read_b128 v[8:11], v42 offset:57344
    v_cvt_pk_bf16_f32 v100, v64, v65
    v_mul_f32 v66, v36, v66
    v_mul_f32 v67, v36, v67
    s_waitcnt lgkmcnt(3)
    v_mfma_f32_32x32x16_bf16 v[72:87], v[12:15], v[212:215], v[72:87]
    ds_read_b128 v[12:15], v42 offset:58368
    v_cvt_pk_bf16_f32 v101, v66, v67
    v_mul_f32 v68, v36, v68
    v_mul_f32 v69, v36, v69
    s_waitcnt lgkmcnt(3)
    v_mfma_f32_32x32x16_bf16 v[72:87], v[16:19], v[216:219], v[72:87]
    ds_read_b128 v[16:19], v42 offset:59392
    v_cvt_pk_bf16_f32 v102, v68, v69
    v_mul_f32 v70, v36, v70
    v_mul_f32 v71, v36, v71
    s_waitcnt lgkmcnt(3)
    v_mfma_f32_32x32x16_bf16 v[72:87], v[20:23], v[220:223], v[72:87]
    ds_read_b128 v[20:23], v42 offset:60416
    v_cvt_pk_bf16_f32 v103, v70, v71
    v_lshl_add_u32 v32, v3, 6, v44
    ds_write_b128 v32, v[88:91] offset:0
    s_waitcnt lgkmcnt(4)
    v_mfma_f32_32x32x16_bf16 v[72:87], v[8:11], v[224:227], v[72:87]
    ds_read_b128 v[8:11], v42 offset:61440
    ds_write_b128 v32, v[92:95] offset:16
    ds_write_b128 v32, v[96:99] offset:32
    ds_write_b128 v32, v[100:103] offset:48
    s_waitcnt lgkmcnt(7)
    v_mfma_f32_32x32x16_bf16 v[72:87], v[12:15], v[228:231], v[72:87]
    ds_read_b128 v[12:15], v42 offset:62464
    ds_read_b32 v7, v4 offset:20
    v_lshl_add_u32 v32, v3, 5, v44
    v_lshrrev_b32 v24, 2, v1
    v_and_b32 v25, 3, v1
    s_waitcnt lgkmcnt(8)
    v_mfma_f32_32x32x16_bf16 v[72:87], v[16:19], v[232:235], v[72:87]
    ds_read_b128 v[16:19], v42 offset:63488
    v_mul_u32_u24 v24, 208, v24
    v_lshl_add_u32 v24, v25, 3, v24
    s_lshl_b32 s10, s5, 5
    s_waitcnt lgkmcnt(8)
    v_mfma_f32_32x32x16_bf16 v[72:87], v[20:23], v[236:239], v[72:87]
    ds_read_b128 v[20:23], v42 offset:64512
    s_add_u32 s10, s10, 16384
    s_lshr_b32 s11, s5, 1
    s_lshl_b32 s11, s11, 5
    s_waitcnt lgkmcnt(7)
    v_mfma_f32_32x32x16_bf16 v[72:87], v[8:11], v[240:243], v[72:87]
    s_waitcnt lgkmcnt(2)
    v_cmp_eq_u32 vcc, s96, v7
    s_cbranch_vccnz F_17
F_16:
    ds_read_b32 v7, v4 offset:20
    s_add_u32 s84, s84, 1
    s_waitcnt lgkmcnt(0)
    v_cmp_ne_u32 vcc, s96, v7
    s_cmp_gt_u32 s84, 200000
    s_cbranch_scc1 F_17
    s_cbranch_vccnz F_16
F_17:
    ds_read_b128 v[8:11], v2 offset:9216
    s_add_u32 s11, s11, 16512
    v_add_u32 v26, s11, v24
    v_add_u32 v24, s10, v24
    v_mfma_f32_32x32x16_bf16 v[72:87], v[12:15], v[244:247], v[72:87]
    v_mov_b32 v28, s80
    v_mov_b32 v29, s80
    v_mov_b32 v30, s80
    s_waitcnt lgkmcnt(2)
    v_mfma_f32_32x32x16_bf16 v[72:87], v[16:19], v[248:251], v[72:87]
    v_mov_b32 v31, s80
    v_cmp_eq_u32 s[12:13], 1, v25
    v_cmp_eq_u32 s[14:15], 2, v25
    s_waitcnt lgkmcnt(1)
    v_mfma_f32_32x32x16_bf16 v[72:87], v[20:23], v[252:255], v[72:87]
    s_lshl_b32 s10, s4, 2
    s_add_u32 s10, s10, s5
    s_lshl_b32 s85, s10, 14
    s_waitcnt lgkmcnt(0)
    v_mfma_f32_32x32x16_bf16 v[72:87], v[8:11], v[52:55], v[72:87]
    s_lshl_b32 s10, s3, 10
    s_add_u32 s85, s85, s10
    s_add_u32 s85, s85, 1048576
    s_mov_b64 exec, 1
    ds_write_b8 v0, v5 offset:32
    s_mov_b64 exec, -1
    ds_read_b32 v7, v4 offset:32
    s_nop 4
    v_mul_f32 v72, v46, v72
    v_mul_f32 v73, v46, v73
    v_cvt_pk_bf16_f32 v88, v72, v73
    v_mul_f32 v74, v46, v74
    v_mul_f32 v75, v46, v75
    v_cvt_pk_bf16_f32 v89, v74, v75
    v_mul_f32 v76, v46, v76
    v_mul_f32 v77, v46, v77
    v_cvt_pk_bf16_f32 v90, v76, v77
    v_mul_f32 v78, v46, v78
    v_mul_f32 v79, v46, v79
    v_cvt_pk_bf16_f32 v91, v78, v79
    ds_write_b128 v32, v[88:91] offset:128
    v_mul_f32 v80, v46, v80
    v_mul_f32 v81, v46, v81
    v_cvt_pk_bf16_f32 v92, v80, v81
    v_mul_f32 v82, v46, v82
    v_mul_f32 v83, v46, v83
    v_cvt_pk_bf16_f32 v93, v82, v83
    v_mul_f32 v84, v46, v84
    v_mul_f32 v85, v46, v85
    v_cvt_pk_bf16_f32 v94, v84, v85
    v_mul_f32 v86, v46, v86
    v_mul_f32 v87, v46, v87
    v_cvt_pk_bf16_f32 v95, v86, v87
    ds_write_b128 v32, v[92:95] offset:144
    s_mov_b64 exec, 1
    ds_write_b8 v0, v5 offset:36
    s_mov_b64 exec, -1
    s_waitcnt lgkmcnt(3)
    v_cmp_eq_u32 vcc, s96, v7
    s_cbranch_vccnz F_21
F_20:
    ds_read_b32 v7, v4 offset:32
    s_add_u32 s84, s84, 1
    s_waitcnt lgkmcnt(0)
    v_cmp_ne_u32 vcc, s96, v7
    s_cmp_gt_u32 s84, 200000
    s_cbranch_scc1 F_21
    s_cbranch_vccnz F_20
F_21:
    ds_read_b32 v6, v4 offset:36
    ds_read_b64_tr_b16 v[56:57], v24 offset:0
    ds_read_b64_tr_b16 v[58:59], v24 offset:3328
    ds_read_b64_tr_b16 v[60:61], v24 offset:20480
    ds_read_b64_tr_b16 v[62:63], v24 offset:23808
    ds_read_b64_tr_b16 v[64:65], v24 offset:40960
    ds_read_b64_tr_b16 v[66:67], v24 offset:44288
    ds_read_b64_tr_b16 v[68:69], v24 offset:61440
    ds_read_b64_tr_b16 v[70:71], v24 offset:64768
    v_mov_b32 v23, s6
    s_waitcnt lgkmcnt(8)
    v_cmp_eq_u32 vcc, s96, v6
    s_cbranch_vccnz F_23
F_22:
    ds_read_b32 v6, v4 offset:36
    s_add_u32 s84, s84, 1
    s_waitcnt lgkmcnt(0)
    v_cmp_ne_u32 vcc, s96, v6
    s_cmp_gt_u32 s84, 200000
    s_cbranch_scc1 F_23
    s_cbranch_vccnz F_22
F_23:
    ds_read_b64_tr_b16 v[72:73], v26 offset:0
    ds_read_b64_tr_b16 v[74:75], v26 offset:3328
    ds_read_b64_tr_b16 v[76:77], v26 offset:20480
    ds_read_b64_tr_b16 v[78:79], v26 offset:23808
    ds_read_b64_tr_b16 v[80:81], v26 offset:40960
    ds_read_b64_tr_b16 v[82:83], v26 offset:44288
    ds_read_b64_tr_b16 v[84:85], v26 offset:61440
    ds_read_b64_tr_b16 v[86:87], v26 offset:64768
    ds_read_b32 v7, v4 offset:24
    v_cmp_eq_u32 vcc, 3, v25
    s_waitcnt lgkmcnt(15)
    v_mfma_f32_16x16x32_bf16 v[16:19], v[56:59], v[28:31], 0
    s_waitcnt lgkmcnt(13)
    v_mfma_f32_16x16x32_bf16 v[16:19], v[60:63], v[28:31], v[16:19]
    s_waitcnt lgkmcnt(11)
    v_mfma_f32_16x16x32_bf16 v[16:19], v[64:67], v[28:31], v[16:19]
    s_waitcnt lgkmcnt(9)
    v_mfma_f32_16x16x32_bf16 v[16:19], v[68:71], v[28:31], v[16:19]
    s_waitcnt lgkmcnt(7)
    v_mfma_f32_16x16x32_bf16 v[12:15], v[56:59], v[72:75], 0
    s_waitcnt lgkmcnt(5)
    v_mfma_f32_16x16x32_bf16 v[12:15], v[60:63], v[76:79], v[12:15]
    s_waitcnt lgkmcnt(3)
    v_mfma_f32_16x16x32_bf16 v[12:15], v[64:67], v[80:83], v[12:15]
    s_waitcnt lgkmcnt(1)
    v_mfma_f32_16x16x32_bf16 v[12:15], v[68:71], v[84:87], v[12:15]
    s_nop 7
    v_cvt_pk_bf16_f32 v20, v12, v13
    v_cvt_pk_bf16_f32 v21, v14, v15
    v_cndmask_b32 v22, v16, v19, vcc
    v_cndmask_b32 v22, v22, v17, s[12:13]
    v_cndmask_b32 v22, v22, v18, s[14:15]
    buffer_store_dwordx4 v[20:23], v2, s[76:79], s85 offen sc1
    s_mov_b64 exec, 1
    ds_write_b8 v0, v5 offset:108
    s_mov_b64 exec, -1
    v_and_b32 v24, 15, v1
    v_lshlrev_b32 v36, 7, v24
    s_lshl_b32 s85, s3, 11
    s_add_u32 s85, s85, 32768
    v_and_b32 v24, 31, v1
    v_bfe_u32 v25, v1, 2, 2
    v_xor_b32 v25, v25, v3
    v_lshlrev_b32 v25, 4, v25
    v_lshl_add_u32 v24, v24, 6, v25
    s_add_u32 s10, s86, 24576
    v_add_u32 v24, s10, v24
    v_xor_b32 v25, 32, v24
    v_add_u32 v42, 28672, v2
    v_add_u32 v43, 69632, v2
    s_waitcnt vmcnt(1)
    buffer_load_dwordx2 v[34:35], v36, s[76:79], s85 offen sc1
    ds_read_b128 v[104:107], v24
    ds_read_b128 v[108:111], v25
    s_waitcnt lgkmcnt(3)
    v_cmp_eq_u32 vcc, s96, v7
    s_cbranch_vccnz F_25
F_24:
    ds_read_b32 v7, v4 offset:24
    s_add_u32 s84, s84, 1
    s_waitcnt lgkmcnt(0)
    v_cmp_ne_u32 vcc, s96, v7
    s_cmp_gt_u32 s84, 200000
    s_cbranch_scc1 F_25
    s_cbranch_vccnz F_24
F_25:
    ds_read_b128 v[8:11], v42 offset:0
    ds_read_b128 v[12:15], v42 offset:1024
    ds_read_b128 v[16:19], v42 offset:2048
    ds_read_b128 v[20:23], v42 offset:3072
    v_bfe_u32 v24, v1, 2, 2
    s_waitcnt lgkmcnt(3)
    v_mfma_f32_32x32x16_bf16 v[56:71], v[8:11], v[128:131], 0
    ds_read_b128 v[8:11], v42 offset:4096
    v_lshlrev_b32 v24, 7, v24
    s_waitcnt lgkmcnt(3)
    v_mfma_f32_32x32x16_bf16 v[56:71], v[12:15], v[132:135], v[56:71]
    ds_read_b128 v[12:15], v42 offset:5120
    v_lshl_add_u32 v24, v3, 10, v24
    s_waitcnt lgkmcnt(3)
    v_mfma_f32_32x32x16_bf16 v[56:71], v[16:19], v[136:139], v[56:71]
    ds_read_b128 v[16:19], v42 offset:6144
    v_bfe_u32 v25, v1, 3, 1
    s_waitcnt lgkmcnt(3)
    v_mfma_f32_32x32x16_bf16 v[56:71], v[20:23], v[140:143], v[56:71]
    ds_read_b128 v[20:23], v42 offset:7168
    v_lshl_add_u32 v24, v25, 6, v24
    s_waitcnt lgkmcnt(3)
    v_mfma_f32_32x32x16_bf16 v[56:71], v[8:11], v[144:147], v[56:71]
    ds_read_b128 v[8:11], v42 offset:20480
    v_bfe_u32 v25, v1, 4, 1
    s_waitcnt lgkmcnt(3)
    v_mfma_f32_32x32x16_bf16 v[56:71], v[12:15], v[148:151], v[56:71]
    ds_read_b128 v[12:15], v42 offset:21504
    v_lshl_add_u32 v24, v25, 5, v24
    s_waitcnt lgkmcnt(3)
    v_mfma_f32_32x32x16_bf16 v[56:71], v[16:19], v[152:155], v[56:71]
    ds_read_b128 v[16:19], v42 offset:22528
    v_and_b32 v25, 1, v1
    s_waitcnt lgkmcnt(3)
    v_mfma_f32_32x32x16_bf16 v[56:71], v[20:23], v[156:159], v[56:71]
    ds_read_b128 v[20:23], v42 offset:23552
    v_lshl_add_u32 v24, v25, 4, v24
    s_waitcnt lgkmcnt(3)
    v_mfma_f32_32x32x16_bf16 v[56:71], v[8:11], v[160:163], v[56:71]
    ds_read_b128 v[8:11], v42 offset:24576
    v_bfe_u32 v25, v1, 1, 1
    s_waitcnt lgkmcnt(3)
    v_mfma_f32_32x32x16_bf16 v[56:71], v[12:15], v[164:167], v[56:71]
    ds_read_b128 v[12:15], v42 offset:25600
    v_lshl_add_u32 v24, v25, 3, v24
    s_waitcnt lgkmcnt(3)
    v_mfma_f32_32x32x16_bf16 v[56:71], v[16:19], v[168:171], v[56:71]
    ds_read_b128 v[16:19], v42 offset:26624
    s_and_b32 s11, s5, 1
    s_waitcnt lgkmcnt(3)
    v_mfma_f32_32x32x16_bf16 v[56:71], v[20:23], v[172:175], v[56:71]
    ds_read_b128 v[20:23], v42 offset:27648
    s_lshl_b32 s10, s11, 6
    s_waitcnt lgkmcnt(3)
    v_mfma_f32_32x32x16_bf16 v[56:71], v[8:11], v[176:179], v[56:71]
    ds_read_b128 v[8:11], v43 offset:0
    v_xor_b32 v33, s10, v24
    s_waitcnt lgkmcnt(3)
    v_mfma_f32_32x32x16_bf16 v[56:71], v[12:15], v[180:183], v[56:71]
    ds_read_b128 v[12:15], v43 offset:1024
    v_xor_b32 v37, 64, v33
    s_waitcnt lgkmcnt(3)
    v_mfma_f32_32x32x16_bf16 v[56:71], v[16:19], v[184:187], v[56:71]
    ds_read_b128 v[16:19], v43 offset:2048
    s_lshl_b32 s10, s11, 15
    s_waitcnt lgkmcnt(3)
    v_mfma_f32_32x32x16_bf16 v[56:71], v[20:23], v[188:191], v[56:71]
    ds_read_b128 v[20:23], v43 offset:3072
    s_add_u32 s10, s10, 98304
    s_waitcnt lgkmcnt(3)
    v_mfma_f32_32x32x16_bf16 v[56:71], v[8:11], v[192:195], v[56:71]
    ds_read_b128 v[8:11], v43 offset:4096
    v_add_u32 v30, s10, v33
    s_waitcnt lgkmcnt(3)
    v_mfma_f32_32x32x16_bf16 v[56:71], v[12:15], v[196:199], v[56:71]
    ds_read_b128 v[12:15], v43 offset:5120
    v_add_u32 v31, s10, v37
    s_waitcnt lgkmcnt(3)
    v_mfma_f32_32x32x16_bf16 v[56:71], v[16:19], v[200:203], v[56:71]
    ds_read_b128 v[16:19], v43 offset:6144
    v_bfe_u32 v28, v1, 2, 1
    s_waitcnt lgkmcnt(3)
    v_mfma_f32_32x32x16_bf16 v[56:71], v[20:23], v[204:207], v[56:71]
    ds_read_b128 v[20:23], v43 offset:7168
    v_bfe_u32 v29, v1, 3, 1
    s_waitcnt lgkmcnt(3)
    v_mfma_f32_32x32x16_bf16 v[56:71], v[8:11], v[208:211], v[56:71]
    ds_read_b128 v[8:11], v43 offset:20480
    v_and_b32 v26, 3, v1
    s_waitcnt lgkmcnt(3)
    v_mfma_f32_32x32x16_bf16 v[56:71], v[12:15], v[212:215], v[56:71]
    ds_read_b128 v[12:15], v43 offset:21504
    v_lshl_add_u32 v26, v28, 3, v26
    s_waitcnt lgkmcnt(3)
    v_mfma_f32_32x32x16_bf16 v[56:71], v[16:19], v[216:219], v[56:71]
    ds_read_b128 v[16:19], v43 offset:22528
    v_lshl_add_u32 v26, v29, 2, v26
    s_waitcnt lgkmcnt(3)
    v_mfma_f32_32x32x16_bf16 v[56:71], v[20:23], v[220:223], v[56:71]
    ds_read_b128 v[20:23], v43 offset:23552
    v_lshl_add_u32 v26, v3, 4, v26
    s_waitcnt lgkmcnt(3)
    v_mfma_f32_32x32x16_bf16 v[56:71], v[8:11], v[224:227], v[56:71]
    ds_read_b128 v[8:11], v43 offset:24576
    v_mul_u32_u24 v26, 80, v26
    s_waitcnt lgkmcnt(3)
    v_mfma_f32_32x32x16_bf16 v[56:71], v[12:15], v[228:231], v[56:71]
    ds_read_b128 v[12:15], v43 offset:25600
    v_add_u32 v26, 4096, v26
    s_waitcnt lgkmcnt(3)
    v_mfma_f32_32x32x16_bf16 v[56:71], v[16:19], v[232:235], v[56:71]
    ds_read_b128 v[16:19], v43 offset:26624
    v_lshlrev_b32 v27, 6, v3
    s_waitcnt lgkmcnt(3)
    v_mfma_f32_32x32x16_bf16 v[56:71], v[20:23], v[236:239], v[56:71]
    ds_read_b128 v[20:23], v43 offset:27648
    v_add_u32 v27, 6656, v27
    s_waitcnt lgkmcnt(3)
    v_mfma_f32_32x32x16_bf16 v[56:71], v[8:11], v[240:243], v[56:71]
    ds_read_b128 v[8:11], v2 offset:10240
    v_bfe_u32 v28, v1, 4, 1
    s_waitcnt lgkmcnt(3)
    v_mfma_f32_32x32x16_bf16 v[56:71], v[12:15], v[244:247], v[56:71]
    v_cmp_eq_u32 vcc, v28, v3
    s_waitcnt lgkmcnt(2)
    v_mfma_f32_32x32x16_bf16 v[56:71], v[16:19], v[248:251], v[56:71]
    v_mov_b32 v29, 6912
    s_waitcnt lgkmcnt(1)
    v_mfma_f32_32x32x16_bf16 v[56:71], v[20:23], v[252:255], v[56:71]
    v_cndmask_b32 v26, v29, v26, vcc
    s_waitcnt lgkmcnt(0)
    v_mfma_f32_32x32x16_bf16 v[56:71], v[8:11], v[52:55], v[56:71]
    v_cndmask_b32 v27, v29, v27, vcc
    s_mov_b64 exec, 1
    ds_write_b8 v0, v5 offset:40
    s_mov_b64 exec, -1
    s_nop 7
    v_max3_f32 v38, v56, v57, v58
    v_min3_f32 v39, v56, v57, v58
    v_max3_f32 v38, v38, v59, v60
    v_min3_f32 v39, v39, v59, v60
    v_max3_f32 v38, v38, v61, v62
    v_min3_f32 v39, v39, v61, v62
    v_max3_f32 v38, v38, v63, v64
    v_min3_f32 v39, v39, v63, v64
    v_max3_f32 v38, v38, v65, v66
    v_min3_f32 v39, v39, v65, v66
    v_max3_f32 v38, v38, v67, v68
    v_min3_f32 v39, v39, v67, v68
    v_max3_f32 v38, v38, v69, v70
    v_min3_f32 v39, v39, v69, v70
    v_max_f32 v38, v38, v71
    v_min_f32 v39, v39, v71
    v_mul_f32 v38, v47, v38
    v_mul_f32 v39, v47, v39
    v_fma_f32 v112, v56, v47, -v38
    v_fma_f32 v56, -v56, v47, v39
    v_exp_f32 v112, v112
    v_exp_f32 v56, v56
    v_fma_f32 v113, v57, v47, -v38
    v_fma_f32 v57, -v57, v47, v39
    v_exp_f32 v113, v113
    v_exp_f32 v57, v57
    v_fma_f32 v114, v58, v47, -v38
    v_fma_f32 v58, -v58, v47, v39
    v_exp_f32 v114, v114
    v_exp_f32 v58, v58
    v_add_f32 v41, v112, v113
    v_add_f32 v45, v56, v57
    v_fma_f32 v115, v59, v47, -v38
    v_fma_f32 v59, -v59, v47, v39
    v_exp_f32 v115, v115
    v_exp_f32 v59, v59
    v_add_f32 v41, v41, v114
    v_add_f32 v45, v45, v58
    v_fma_f32 v116, v60, v47, -v38
    v_fma_f32 v60, -v60, v47, v39
    v_exp_f32 v116, v116
    v_exp_f32 v60, v60
    v_add_f32 v41, v41, v115
    v_add_f32 v45, v45, v59
    v_fma_f32 v117, v61, v47, -v38
    v_fma_f32 v61, -v61, v47, v39
    v_exp_f32 v117, v117
    v_exp_f32 v61, v61
    v_add_f32 v41, v41, v116
    v_add_f32 v45, v45, v60
    v_fma_f32 v118, v62, v47, -v38
    v_fma_f32 v62, -v62, v47, v39
    ds_read_b32 v6, v4 offset:44
    v_exp_f32 v118, v118
    v_exp_f32 v62, v62
    v_add_f32 v41, v41, v117
    v_add_f32 v45, v45, v61
    v_fma_f32 v119, v63, v47, -v38
    v_fma_f32 v63, -v63, v47, v39
    v_exp_f32 v119, v119
    v_exp_f32 v63, v63
    s_waitcnt lgkmcnt(0)
    v_cmp_eq_u32 vcc, s96, v6
    s_cbranch_vccnz F_27
F_26:
    ds_read_b32 v6, v4 offset:44
    s_add_u32 s84, s84, 1
    s_waitcnt lgkmcnt(0)
    v_cmp_ne_u32 vcc, s96, v6
    s_cmp_gt_u32 s84, 200000
    s_cbranch_scc1 F_27
    s_cbranch_vccnz F_26
F_27:
    ds_read_b64_tr_b16 v[128:129], v30 offset:0
    ds_read_b64_tr_b16 v[130:131], v30 offset:512
    ds_read_b64_tr_b16 v[132:133], v31 offset:0
    ds_read_b64_tr_b16 v[134:135], v31 offset:512
    v_add_f32 v41, v41, v118
    v_add_f32 v45, v45, v62
    v_fma_f32 v120, v64, v47, -v38
    v_fma_f32 v64, -v64, v47, v39
    v_exp_f32 v120, v120
    v_exp_f32 v64, v64
    ds_read_b64_tr_b16 v[136:137], v30 offset:2048
    ds_read_b64_tr_b16 v[138:139], v30 offset:2560
    ds_read_b64_tr_b16 v[140:141], v31 offset:2048
    ds_read_b64_tr_b16 v[142:143], v31 offset:2560
    v_add_f32 v41, v41, v119
    v_add_f32 v45, v45, v63
    v_fma_f32 v121, v65, v47, -v38
    v_fma_f32 v65, -v65, v47, v39
    v_exp_f32 v121, v121
    v_exp_f32 v65, v65
    ds_read_b64_tr_b16 v[144:145], v30 offset:4096
    ds_read_b64_tr_b16 v[146:147], v30 offset:4608
    ds_read_b64_tr_b16 v[148:149], v31 offset:4096
    ds_read_b64_tr_b16 v[150:151], v31 offset:4608
    v_add_f32 v41, v41, v120
    v_add_f32 v45, v45, v64
    v_fma_f32 v122, v66, v47, -v38
    v_fma_f32 v66, -v66, v47, v39
    v_exp_f32 v122, v122
    v_exp_f32 v66, v66
    v_add_f32 v41, v41, v121
    ds_read_b64_tr_b16 v[152:153], v30 offset:6144
    ds_read_b64_tr_b16 v[154:155], v30 offset:6656
    ds_read_b64_tr_b16 v[156:157], v31 offset:6144
    ds_read_b64_tr_b16 v[158:159], v31 offset:6656
    v_add_f32 v45, v45, v65
    v_fma_f32 v123, v67, v47, -v38
    v_fma_f32 v67, -v67, v47, v39
    v_exp_f32 v123, v123
    v_exp_f32 v67, v67
    v_add_f32 v41, v41, v122
    ds_read_b64_tr_b16 v[160:161], v30 offset:8192
    ds_read_b64_tr_b16 v[162:163], v30 offset:8704
    ds_read_b64_tr_b16 v[164:165], v31 offset:8192
    ds_read_b64_tr_b16 v[166:167], v31 offset:8704
    v_add_f32 v45, v45, v66
    v_fma_f32 v124, v68, v47, -v38
    v_fma_f32 v68, -v68, v47, v39
    v_exp_f32 v124, v124
    v_exp_f32 v68, v68
    v_add_f32 v41, v41, v123
    ds_read_b64_tr_b16 v[168:169], v30 offset:10240
    ds_read_b64_tr_b16 v[170:171], v30 offset:10752
    ds_read_b64_tr_b16 v[172:173], v31 offset:10240
    ds_read_b64_tr_b16 v[174:175], v31 offset:10752
    v_add_f32 v45, v45, v67
    v_fma_f32 v125, v69, v47, -v38
    v_fma_f32 v69, -v69, v47, v39
    v_exp_f32 v125, v125
    v_exp_f32 v69, v69
    v_add_f32 v41, v41, v124
    v_add_f32 v45, v45, v68
    ds_read_b64_tr_b16 v[176:177], v30 offset:12288
    ds_read_b64_tr_b16 v[178:179], v30 offset:12800
    ds_read_b64_tr_b16 v[180:181], v31 offset:12288
    ds_read_b64_tr_b16 v[182:183], v31 offset:12800
    v_fma_f32 v126, v70, v47, -v38
    v_fma_f32 v70, -v70, v47, v39
    v_exp_f32 v126, v126
    v_exp_f32 v70, v70
    v_add_f32 v41, v41, v125
    v_add_f32 v45, v45, v69
    ds_read_b64_tr_b16 v[184:185], v30 offset:14336
    ds_read_b64_tr_b16 v[186:187], v30 offset:14848
    ds_read_b64_tr_b16 v[188:189], v31 offset:14336
    ds_read_b64_tr_b16 v[190:191], v31 offset:14848
    v_fma_f32 v127, v71, v47, -v38
    v_fma_f32 v71, -v71, v47, v39
    v_exp_f32 v127, v127
    v_exp_f32 v71, v71
    v_add_f32 v41, v41, v126
    v_add_f32 v45, v45, v70
    v_add_f32 v41, v41, v127
    ds_read_b64_tr_b16 v[192:193], v30 offset:16384
    ds_read_b64_tr_b16 v[194:195], v30 offset:16896
    ds_read_b64_tr_b16 v[196:197], v31 offset:16384
    ds_read_b64_tr_b16 v[198:199], v31 offset:16896
    v_add_f32 v45, v45, v71
    v_rcp_f32 v41, v41
    v_rcp_f32 v45, v45
    v_mul_f32 v112, v41, v112
    v_mul_f32 v113, v41, v113
    v_cvt_pk_bf16_f32 v88, v112, v113
    ds_read_b64_tr_b16 v[200:201], v30 offset:18432
    ds_read_b64_tr_b16 v[202:203], v30 offset:18944
    ds_read_b64_tr_b16 v[204:205], v31 offset:18432
    ds_read_b64_tr_b16 v[206:207], v31 offset:18944
    v_mul_f32 v114, v41, v114
    v_mul_f32 v115, v41, v115
    v_cvt_pk_bf16_f32 v89, v114, v115
    v_mul_f32 v116, v41, v116
    v_mul_f32 v117, v41, v117
    v_cvt_pk_bf16_f32 v90, v116, v117
    ds_read_b64_tr_b16 v[208:209], v30 offset:20480
    ds_read_b64_tr_b16 v[210:211], v30 offset:20992
    ds_read_b64_tr_b16 v[212:213], v31 offset:20480
    ds_read_b64_tr_b16 v[214:215], v31 offset:20992
    v_mul_f32 v118, v41, v118
    v_mul_f32 v119, v41, v119
    v_cvt_pk_bf16_f32 v91, v118, v119
    v_mul_f32 v120, v41, v120
    v_mul_f32 v121, v41, v121
    v_cvt_pk_bf16_f32 v92, v120, v121
    v_mul_f32 v122, v41, v122
    ds_read_b64_tr_b16 v[216:217], v30 offset:22528
    ds_read_b64_tr_b16 v[218:219], v30 offset:23040
    ds_read_b64_tr_b16 v[220:221], v31 offset:22528
    ds_read_b64_tr_b16 v[222:223], v31 offset:23040
    v_mul_f32 v123, v41, v123
    v_cvt_pk_bf16_f32 v93, v122, v123
    v_mul_f32 v124, v41, v124
    v_mul_f32 v125, v41, v125
    v_cvt_pk_bf16_f32 v94, v124, v125
    v_mul_f32 v126, v41, v126
    ds_read_b64_tr_b16 v[224:225], v30 offset:24576
    ds_read_b64_tr_b16 v[226:227], v30 offset:25088
    ds_read_b64_tr_b16 v[228:229], v31 offset:24576
    ds_read_b64_tr_b16 v[230:231], v31 offset:25088
    v_mul_f32 v127, v41, v127
    v_cvt_pk_bf16_f32 v95, v126, v127
    v_mul_f32 v56, v45, v56
    v_mul_f32 v57, v45, v57
    v_cvt_pk_bf16_f32 v96, v56, v57
    v_mul_f32 v58, v45, v58
    ds_read_b64_tr_b16 v[232:233], v30 offset:26624
    ds_read_b64_tr_b16 v[234:235], v30 offset:27136
    ds_read_b64_tr_b16 v[236:237], v31 offset:26624
    ds_read_b64_tr_b16 v[238:239], v31 offset:27136
    v_mul_f32 v59, v45, v59
    v_cvt_pk_bf16_f32 v97, v58, v59
    v_mul_f32 v60, v45, v60
    v_mul_f32 v61, v45, v61
    v_cvt_pk_bf16_f32 v98, v60, v61
    v_mul_f32 v62, v45, v62
    v_mul_f32 v63, v45, v63
    ds_read_b64_tr_b16 v[240:241], v30 offset:28672
    ds_read_b64_tr_b16 v[242:243], v30 offset:29184
    ds_read_b64_tr_b16 v[244:245], v31 offset:28672
    ds_read_b64_tr_b16 v[246:247], v31 offset:29184
    v_cvt_pk_bf16_f32 v99, v62, v63
    v_mul_f32 v64, v45, v64
    v_mul_f32 v65, v45, v65
    v_cvt_pk_bf16_f32 v100, v64, v65
    v_mul_f32 v66, v45, v66
    v_mul_f32 v67, v45, v67
    ds_read_b64_tr_b16 v[248:249], v30 offset:30720
    ds_read_b64_tr_b16 v[250:251], v30 offset:31232
    ds_read_b64_tr_b16 v[252:253], v31 offset:30720
    ds_read_b64_tr_b16 v[254:255], v31 offset:31232
    s_mov_b64 exec, 1
    ds_write_b8 v0, v5 offset:48
    s_mov_b64 exec, -1
    v_cvt_pk_bf16_f32 v101, v66, v67
    v_mul_f32 v68, v45, v68
    v_mul_f32 v69, v45, v69
    v_cvt_pk_bf16_f32 v102, v68, v69
    v_mul_f32 v70, v45, v70
    v_mul_f32 v71, v45, v71
    v_cvt_pk_bf16_f32 v103, v70, v71
    ds_read_b32 v6, v4 offset:52
    s_getreg_b32 s10, hwreg(HW_REG_XCC_ID, 0, 4)
    s_waitcnt vmcnt(0)
    v_cmp_ne_u32 vcc, s6, v35
    s_cbranch_vccz X_29
X_28:
    buffer_load_dwordx2 v[34:35], v36, s[76:79], s85 offen sc1
    s_add_u32 s84, s84, 8
    s_waitcnt vmcnt(0)
    v_cmp_ne_u32 vcc, s6, v35
    s_cmp_gt_u32 s84, 200000
    s_cbranch_scc1 X_29
    s_cbranch_vccnz X_28
X_29:
    v_cmp_ne_u32 vcc, s10, v34
    v_mov_b32 v38, s6
    s_lshl_b32 s10, s3, 2
    s_add_u32 s10, s10, s5
    s_lshl_b32 s68, s10, 13
    s_mul_i32 s10, s10, 43
    s_add_u32 s10, s10, s4
    s_lshl_b32 s10, s10, 11
    s_add_u32 s85, s10, 6291456
    s_cmp_eq_u64 vcc, 0
    s_cselect_b32 s97, 1, 0
    s_cselect_b32 s98, 2, 7
    s_add_u32 s68, s68, 131072
    s_lshl_b32 s10, s4, s98
    s_add_u32 s69, s68, s10
    s_lshl_b32 s70, s87, 13
    s_add_u32 s70, s70, 131072
    s_and_b32 s11, s5, 1
    s_lshl_b32 s11, s11, 3
    v_and_b32 v28, 7, v1
    v_add_u32 v28, s11, v28
    v_lshlrev_b32 v32, s98, v28
    s_waitcnt lgkmcnt(0)
    v_cmp_eq_u32 vcc, s96, v6
    s_cbranch_vccnz F_31
F_30:
    ds_read_b32 v6, v4 offset:52
    s_add_u32 s84, s84, 1
    s_waitcnt lgkmcnt(0)
    v_cmp_ne_u32 vcc, s96, v6
    s_cmp_gt_u32 s84, 200000
    s_cbranch_scc1 F_31
    s_cbranch_vccnz F_30
F_31:
    ds_read_b128 v[8:11], v27 offset:0
    ds_read_b128 v[12:15], v27 offset:16
    ds_read_b128 v[16:19], v27 offset:32
    ds_read_b128 v[20:23], v27 offset:48
    ds_read_b128 v[112:115], v26 offset:0
    ds_read_b128 v[116:119], v26 offset:16
    ds_read_b128 v[120:123], v26 offset:32
    ds_read_b128 v[124:127], v26 offset:48
    s_mov_b64 exec, 1
    ds_write_b8 v0, v5 offset:100
    s_mov_b64 exec, -1
    s_waitcnt lgkmcnt(8)
    v_mfma_f32_32x32x16_bf16 v[72:87], v[8:11], v[88:91], 0
    s_waitcnt lgkmcnt(7)
    v_mfma_f32_32x32x16_bf16 v[72:87], v[12:15], v[92:95], v[72:87]
    s_waitcnt lgkmcnt(6)
    v_mfma_f32_32x32x16_bf16 v[72:87], v[16:19], v[96:99], v[72:87]
    s_waitcnt lgkmcnt(5)
    v_mfma_f32_32x32x16_bf16 v[72:87], v[20:23], v[100:103], v[72:87]
    s_waitcnt lgkmcnt(4)
    v_mfma_f32_32x32x16_bf16 v[56:71], v[112:115], v[88:91], 0
    s_waitcnt lgkmcnt(3)
    v_mfma_f32_32x32x16_bf16 v[56:71], v[116:119], v[92:95], v[56:71]
    s_waitcnt lgkmcnt(2)
    v_mfma_f32_32x32x16_bf16 v[56:71], v[120:123], v[96:99], v[56:71]
    s_waitcnt lgkmcnt(1)
    v_mfma_f32_32x32x16_bf16 v[56:71], v[124:127], v[100:103], v[56:71]
    s_nop 3
    v_add_f32 v24, 0x358637bd, v72
    v_add_f32 v25, 0x358637bd, v80
    v_rcp_f32 v24, v24
    v_rcp_f32 v25, v25
    s_nop 3
    v_mul_f32 v56, v24, v56
    v_mul_f32 v57, v24, v57
    v_cvt_pk_bf16_f32 v8, v56, v57
    v_mul_f32 v58, v24, v58
    v_mul_f32 v59, v24, v59
    v_cvt_pk_bf16_f32 v9, v58, v59
    v_mul_f32 v60, v24, v60
    v_mul_f32 v61, v24, v61
    v_cvt_pk_bf16_f32 v10, v60, v61
    v_mul_f32 v62, v24, v62
    v_mul_f32 v63, v24, v63
    v_cvt_pk_bf16_f32 v11, v62, v63
    s_cmp_eq_u32 s97, 0
    s_cbranch_scc1 A_32
    buffer_store_dwordx4 v[8:11], v2, s[76:79], s85 offen offset:0
B_33:
    v_mul_f32 v64, v25, v64
    v_mul_f32 v65, v25, v65
    v_cvt_pk_bf16_f32 v12, v64, v65
    v_mul_f32 v66, v25, v66
    v_mul_f32 v67, v25, v67
    v_cvt_pk_bf16_f32 v13, v66, v67
    v_mul_f32 v68, v25, v68
    v_mul_f32 v69, v25, v69
    v_cvt_pk_bf16_f32 v14, v68, v69
    v_mul_f32 v70, v25, v70
    v_mul_f32 v71, v25, v71
    v_cvt_pk_bf16_f32 v15, v70, v71
    s_cmp_eq_u32 s97, 0
    s_cbranch_scc1 A_34
    buffer_store_dwordx4 v[12:15], v2, s[76:79], s85 offen offset:1024
B_35:
    s_and_b32 s11, s5, 1
    s_mul_i32 s85, s87, 43
    s_lshl3_add_u32 s85, s11, s85
    s_lshl_b32 s85, s85, 11
    s_add_u32 s85, s85, 6291456
    s_lshl_b32 s10, s5, 12
    s_add_u32 s10, s10, 4096
    v_add_u32 v34, s10, v2
    s_xor_b32 s12, s5, 1
    s_lshl_b32 s10, s12, 12
    s_add_u32 s10, s10, 4096
    v_add_u32 v35, s10, v2
    v_mov_b32 v39, s12
    s_lshl_b32 s11, s11, 7
    v_lshlrev_b32 v36, 5, v3
    v_add_u32 v36, s11, v36
    s_waitcnt vmcnt(0)
    s_mov_b64 exec, 1
    s_cmp_eq_u32 s97, 0
    s_cbranch_scc1 A_36
    buffer_store_dword v38, off, s[76:79], s69
B_37:
    s_mov_b64 exec, -1
P_38:
    buffer_load_dword v8, v32, s[76:79], s70 offen sc1
    s_add_u32 s84, s84, 8
    s_waitcnt vmcnt(0)
    v_cmp_ne_u32 vcc, s6, v8
    s_cmp_gt_u32 s84, 200000
    s_cbranch_scc1 P_39
    s_cbranch_vccnz P_38
P_39:
    s_mov_b32 s89, s85
    s_add_u32 s88, s89, 0
    buffer_load_dwordx4 v[8:11], v2, s[76:79], s88 offen offset:0 sc1
    buffer_load_dwordx4 v[12:15], v2, s[76:79], s88 offen offset:1024 sc1
    buffer_load_dwordx4 v[16:19], v2, s[76:79], s88 offen offset:2048 sc1
    buffer_load_dwordx4 v[20:23], v2, s[76:79], s88 offen offset:3072 sc1
    s_add_u32 s88, s89, 4096
    buffer_load_dwordx4 v[24:27], v2, s[76:79], s88 offen offset:0 sc1
    buffer_load_dwordx4 v[28:31], v2, s[76:79], s88 offen offset:1024 sc1
    buffer_load_dwordx4 v[76:79], v2, s[76:79], s88 offen offset:2048 sc1
    buffer_load_dwordx4 v[80:83], v2, s[76:79], s88 offen offset:3072 sc1
    s_add_u32 s88, s89, 8192
    buffer_load_dwordx4 v[84:87], v2, s[76:79], s88 offen offset:0 sc1
    buffer_load_dwordx4 v[88:91], v2, s[76:79], s88 offen offset:1024 sc1
    buffer_load_dwordx4 v[92:95], v2, s[76:79], s88 offen offset:2048 sc1
    buffer_load_dwordx4 v[96:99], v2, s[76:79], s88 offen offset:3072 sc1
    s_add_u32 s88, s89, 12288
    buffer_load_dwordx4 v[100:103], v2, s[76:79], s88 offen offset:0 sc1
    buffer_load_dwordx4 v[112:115], v2, s[76:79], s88 offen offset:1024 sc1
    buffer_load_dwordx4 v[116:119], v2, s[76:79], s88 offen offset:2048 sc1
    buffer_load_dwordx4 v[120:123], v2, s[76:79], s88 offen offset:3072 sc1
    s_mov_b64 exec, 1
    ds_write_b8 v0, v5 offset:104
    s_mov_b64 exec, -1
    ds_read_b32 v6, v4 offset:56
    s_lshl_b32 s85, s87, 4
    s_add_u32 s85, s85, s99
    s_lshl_b32 s86, s85, 8
    s_lshl_b32 s85, s85, 11
    s_add_u32 s85, s85, 0
    s_and_b32 s11, s5, 1
    s_mul_i32 s11, s11, 248
    s_sub_u32 s86, s86, s11
    s_add_u32 s86, s86, 786432
    s_lshl_b32 s71, s99, s98
    s_add_u32 s71, s71, s70
    s_add_u32 s71, s71, 2048
    v_and_b32 v41, 0x1f0, v2
    s_waitcnt vmcnt(15)
    v_mfma_f32_32x32x16_bf16 v[60:75], v[132:135], v[8:11], 0
    v_mfma_f32_32x32x16_bf16 v[44:59], v[128:131], v[8:11], 0
    s_waitcnt vmcnt(14)
    v_mfma_f32_32x32x16_bf16 v[60:75], v[140:143], v[12:15], v[60:75]
    v_mfma_f32_32x32x16_bf16 v[44:59], v[136:139], v[12:15], v[44:59]
    s_waitcnt vmcnt(13)
    v_mfma_f32_32x32x16_bf16 v[60:75], v[148:151], v[16:19], v[60:75]
    v_mfma_f32_32x32x16_bf16 v[44:59], v[144:147], v[16:19], v[44:59]
    s_waitcnt vmcnt(12)
    v_mfma_f32_32x32x16_bf16 v[60:75], v[156:159], v[20:23], v[60:75]
    v_mfma_f32_32x32x16_bf16 v[44:59], v[152:155], v[20:23], v[44:59]
    s_waitcnt vmcnt(11)
    v_mfma_f32_32x32x16_bf16 v[60:75], v[164:167], v[24:27], v[60:75]
    v_mfma_f32_32x32x16_bf16 v[44:59], v[160:163], v[24:27], v[44:59]
    s_waitcnt lgkmcnt(0)
    v_cmp_eq_u32 vcc, s96, v6
    s_cbranch_vccnz F_41
F_40:
    ds_read_b32 v6, v4 offset:56
    s_add_u32 s84, s84, 1
    s_waitcnt lgkmcnt(0)
    v_cmp_ne_u32 vcc, s96, v6
    s_cmp_gt_u32 s84, 200000
    s_cbranch_scc1 F_41
    s_cbranch_vccnz F_40
F_41:
    ds_read_b128 v[128:131], v36 offset:128
    ds_read_b128 v[144:147], v36 offset:384
    ds_read_b128 v[132:135], v36 offset:144
    ds_read_b128 v[148:151], v36 offset:400
    ds_read_b128 v[136:139], v36 offset:192
    ds_read_b128 v[152:155], v36 offset:448
    ds_read_b128 v[140:143], v36 offset:208
    ds_read_b128 v[156:159], v36 offset:464
    s_waitcnt vmcnt(10)
    v_mfma_f32_32x32x16_bf16 v[60:75], v[172:175], v[28:31], v[60:75]
    v_mfma_f32_32x32x16_bf16 v[44:59], v[168:171], v[28:31], v[44:59]
    s_waitcnt vmcnt(9)
    v_mfma_f32_32x32x16_bf16 v[60:75], v[180:183], v[76:79], v[60:75]
    v_mfma_f32_32x32x16_bf16 v[44:59], v[176:179], v[76:79], v[44:59]
    s_waitcnt vmcnt(8)
    v_mfma_f32_32x32x16_bf16 v[60:75], v[188:191], v[80:83], v[60:75]
    v_mfma_f32_32x32x16_bf16 v[44:59], v[184:187], v[80:83], v[44:59]
    s_waitcnt vmcnt(7)
    v_mfma_f32_32x32x16_bf16 v[60:75], v[196:199], v[84:87], v[60:75]
    v_mfma_f32_32x32x16_bf16 v[44:59], v[192:195], v[84:87], v[44:59]
    ds_read_b32 v6, v4 offset:120
    ds_read_b32 v7, v4 offset:100
    v_lshlrev_b32 v160, 16, v104
    v_and_b32 v161, 0xffff0000, v104
    v_lshlrev_b32 v162, 16, v105
    v_and_b32 v163, 0xffff0000, v105
    v_lshlrev_b32 v164, 16, v106
    v_and_b32 v165, 0xffff0000, v106
    s_waitcnt vmcnt(6)
    v_mfma_f32_32x32x16_bf16 v[60:75], v[204:207], v[88:91], v[60:75]
    v_mfma_f32_32x32x16_bf16 v[44:59], v[200:203], v[88:91], v[44:59]
    v_lshlrev_b32 v166, 16, v107
    v_and_b32 v167, 0xffff0000, v107
    v_lshlrev_b32 v168, 16, v108
    v_and_b32 v169, 0xffff0000, v108
    v_lshlrev_b32 v170, 16, v109
    v_and_b32 v171, 0xffff0000, v109
    v_lshlrev_b32 v172, 16, v110
    s_waitcnt vmcnt(5)
    v_mfma_f32_32x32x16_bf16 v[60:75], v[212:215], v[92:95], v[60:75]
    v_mfma_f32_32x32x16_bf16 v[44:59], v[208:211], v[92:95], v[44:59]
    v_and_b32 v173, 0xffff0000, v110
    v_lshlrev_b32 v174, 16, v111
    v_and_b32 v175, 0xffff0000, v111
    s_waitcnt lgkmcnt(8)
    v_mul_f32 v176, v144, v160
    v_mul_f32 v144, v144, v128
    v_mul_f32 v177, v145, v161
    v_mul_f32 v145, v145, v129
    s_waitcnt vmcnt(4)
    v_mfma_f32_32x32x16_bf16 v[60:75], v[220:223], v[96:99], v[60:75]
    v_mfma_f32_32x32x16_bf16 v[44:59], v[216:219], v[96:99], v[44:59]
    v_mul_f32 v178, v146, v162
    v_mul_f32 v146, v146, v130
    v_mul_f32 v179, v147, v163
    v_mul_f32 v147, v147, v131
    s_waitcnt lgkmcnt(6)
    v_mul_f32 v180, v148, v164
    v_mul_f32 v148, v148, v132
    v_mul_f32 v181, v149, v165
    s_waitcnt vmcnt(3)
    v_mfma_f32_32x32x16_bf16 v[60:75], v[228:231], v[100:103], v[60:75]
    v_mfma_f32_32x32x16_bf16 v[44:59], v[224:227], v[100:103], v[44:59]
    v_mul_f32 v149, v149, v133
    v_mul_f32 v182, v150, v166
    v_mul_f32 v150, v150, v134
    v_mul_f32 v183, v151, v167
    v_mul_f32 v151, v151, v135
    s_waitcnt lgkmcnt(4)
    v_mul_f32 v184, v152, v168
    v_mul_f32 v152, v152, v136
    s_waitcnt vmcnt(2)
    v_mfma_f32_32x32x16_bf16 v[60:75], v[236:239], v[112:115], v[60:75]
    v_mfma_f32_32x32x16_bf16 v[44:59], v[232:235], v[112:115], v[44:59]
    v_mul_f32 v185, v153, v169
    v_mul_f32 v153, v153, v137
    v_mul_f32 v186, v154, v170
    v_mul_f32 v154, v154, v138
    v_mul_f32 v187, v155, v171
    v_mul_f32 v155, v155, v139
    s_waitcnt lgkmcnt(2)
    v_mul_f32 v188, v156, v172
    s_waitcnt vmcnt(1)
    v_mfma_f32_32x32x16_bf16 v[60:75], v[244:247], v[116:119], v[60:75]
    v_mfma_f32_32x32x16_bf16 v[44:59], v[240:243], v[116:119], v[44:59]
    v_mul_f32 v156, v156, v140
    v_mul_f32 v189, v157, v173
    v_mul_f32 v157, v157, v141
    v_mul_f32 v190, v158, v174
    v_mul_f32 v158, v158, v142
    v_mul_f32 v191, v159, v175
    v_mul_f32 v159, v159, v143
    s_waitcnt lgkmcnt(1)
    v_cmp_eq_u32 vcc, s96, v6
    s_cbranch_vccnz F_43
F_42:
    ds_read_b32 v6, v4 offset:120
    s_add_u32 s84, s84, 1
    s_waitcnt lgkmcnt(0)
    v_cmp_ne_u32 vcc, s96, v6
    s_cmp_gt_u32 s84, 200000
    s_cbranch_scc1 F_43
    s_cbranch_vccnz F_42
F_43:
    s_waitcnt lgkmcnt(0)
    v_cmp_eq_u32 vcc, s96, v7
    s_cbranch_vccnz F_45
F_44:
    ds_read_b32 v7, v4 offset:100
    s_add_u32 s84, s84, 1
    s_waitcnt lgkmcnt(0)
    v_cmp_ne_u32 vcc, s96, v7
    s_cmp_gt_u32 s84, 200000
    s_cbranch_scc1 F_45
    s_cbranch_vccnz F_44
F_45:
    s_waitcnt vmcnt(0)
    v_mfma_f32_32x32x16_bf16 v[60:75], v[252:255], v[120:123], v[60:75]
    v_mfma_f32_32x32x16_bf16 v[44:59], v[248:251], v[120:123], v[44:59]
    s_nop 10
    ds_write_b128 v34, v[60:63] offset:0
    ds_write_b128 v34, v[64:67] offset:1024
    ds_write_b128 v34, v[68:71] offset:2048
    ds_write_b128 v34, v[72:75] offset:3072
    s_mov_b64 exec, 1
    ds_write_b8 v0, v5 offset:60
    s_mov_b64 exec, -1
    v_fma_f32 v176, v144, v44, v176
    v_fma_f32 v177, v145, v45, v177
    v_fma_f32 v178, v146, v46, v178
    v_fma_f32 v179, v147, v47, v179
    ds_read_u8 v6, v39 offset:60
    v_fma_f32 v180, v148, v48, v180
    v_fma_f32 v181, v149, v49, v181
    v_fma_f32 v182, v150, v50, v182
    v_fma_f32 v183, v151, v51, v183
    v_fma_f32 v184, v152, v52, v184
    v_fma_f32 v185, v153, v53, v185
    v_fma_f32 v186, v154, v54, v186
    v_fma_f32 v187, v155, v55, v187
    v_fma_f32 v188, v156, v56, v188
    v_fma_f32 v189, v157, v57, v189
    v_fma_f32 v190, v158, v58, v190
    v_fma_f32 v191, v159, v59, v191
    s_waitcnt lgkmcnt(0)
    v_cmp_eq_u32 vcc, 1, v6
    s_cbranch_vccnz F_47
F_46:
    ds_read_u8 v6, v39 offset:60
    s_add_u32 s84, s84, 1
    s_waitcnt lgkmcnt(0)
    v_cmp_ne_u32 vcc, 1, v6
    s_cmp_gt_u32 s84, 200000
    s_cbranch_scc1 F_47
    s_cbranch_vccnz F_46
F_47:
    ds_read_b128 v[192:195], v35 offset:0
    ds_read_b128 v[196:199], v35 offset:1024
    ds_read_b128 v[200:203], v35 offset:2048
    ds_read_b128 v[204:207], v35 offset:3072
    v_fma_f32 v160, v128, v44, v160
    v_fma_f32 v161, v129, v45, v161
    v_fma_f32 v162, v130, v46, v162
    v_fma_f32 v163, v131, v47, v163
    v_fma_f32 v164, v132, v48, v164
    v_fma_f32 v165, v133, v49, v165
    v_fma_f32 v166, v134, v50, v166
    v_fma_f32 v167, v135, v51, v167
    v_fma_f32 v168, v136, v52, v168
    v_fma_f32 v169, v137, v53, v169
    v_fma_f32 v170, v138, v54, v170
    v_fma_f32 v171, v139, v55, v171
    v_fma_f32 v172, v140, v56, v172
    v_fma_f32 v173, v141, v57, v173
    v_fma_f32 v174, v142, v58, v174
    v_fma_f32 v175, v143, v59, v175
    s_waitcnt lgkmcnt(3)
    v_fma_f32 v176, v144, v192, v176
    v_fma_f32 v177, v145, v193, v177
    v_cvt_pk_bf16_f32 v8, v176, v177
    v_fma_f32 v178, v146, v194, v178
    v_fma_f32 v179, v147, v195, v179
    v_cvt_pk_bf16_f32 v9, v178, v179
    s_waitcnt lgkmcnt(2)
    v_fma_f32 v180, v148, v196, v180
    v_fma_f32 v181, v149, v197, v181
    v_cvt_pk_bf16_f32 v10, v180, v181
    v_fma_f32 v182, v150, v198, v182
    v_fma_f32 v183, v151, v199, v183
    v_cvt_pk_bf16_f32 v11, v182, v183
    s_cmp_eq_u32 s97, 0
    s_cbranch_scc1 A_48
    buffer_store_dwordx4 v[8:11], v2, s[72:75], s85 offen offset:0
B_49:
    s_waitcnt lgkmcnt(1)
    v_fma_f32 v184, v152, v200, v184
    v_fma_f32 v185, v153, v201, v185
    v_cvt_pk_bf16_f32 v12, v184, v185
    v_fma_f32 v186, v154, v202, v186
    v_fma_f32 v187, v155, v203, v187
    v_cvt_pk_bf16_f32 v13, v186, v187
    s_waitcnt lgkmcnt(0)
    v_fma_f32 v188, v156, v204, v188
    v_fma_f32 v189, v157, v205, v189
    v_cvt_pk_bf16_f32 v14, v188, v189
    v_fma_f32 v190, v158, v206, v190
    v_fma_f32 v191, v159, v207, v191
    v_cvt_pk_bf16_f32 v15, v190, v191
    s_cmp_eq_u32 s97, 0
    s_cbranch_scc1 A_50
    buffer_store_dwordx4 v[12:15], v2, s[72:75], s85 offen offset:1024
B_51:
    v_fma_f32 v160, v128, v192, v160
    v_mov_b32 v16, v160
    v_mul_f32 v17, v160, v160
    v_fma_f32 v161, v129, v193, v161
    v_mov_b32 v18, v161
    v_mul_f32 v19, v161, v161
    v_fma_f32 v162, v130, v194, v162
    v_add_f32 v16, v16, v162
    v_fmac_f32 v17, v162, v162
    v_fma_f32 v163, v131, v195, v163
    v_add_f32 v18, v18, v163
    v_fmac_f32 v19, v163, v163
    v_fma_f32 v164, v132, v196, v164
    v_add_f32 v16, v16, v164
    v_fmac_f32 v17, v164, v164
    v_fma_f32 v165, v133, v197, v165
    v_add_f32 v18, v18, v165
    v_fmac_f32 v19, v165, v165
    v_fma_f32 v166, v134, v198, v166
    v_add_f32 v16, v16, v166
    v_fmac_f32 v17, v166, v166
    v_fma_f32 v167, v135, v199, v167
    v_add_f32 v18, v18, v167
    v_fmac_f32 v19, v167, v167
    v_fma_f32 v168, v136, v200, v168
    v_add_f32 v16, v16, v168
    v_fmac_f32 v17, v168, v168
    v_fma_f32 v169, v137, v201, v169
    v_add_f32 v18, v18, v169
    v_fmac_f32 v19, v169, v169
    v_fma_f32 v170, v138, v202, v170
    v_add_f32 v16, v16, v170
    v_fmac_f32 v17, v170, v170
    v_fma_f32 v171, v139, v203, v171
    v_add_f32 v18, v18, v171
    v_fmac_f32 v19, v171, v171
    v_fma_f32 v172, v140, v204, v172
    v_add_f32 v16, v16, v172
    v_fmac_f32 v17, v172, v172
    v_fma_f32 v173, v141, v205, v173
    v_add_f32 v18, v18, v173
    v_fmac_f32 v19, v173, v173
    v_fma_f32 v174, v142, v206, v174
    v_add_f32 v16, v16, v174
    v_fmac_f32 v17, v174, v174
    v_fma_f32 v175, v143, v207, v175
    v_add_f32 v18, v18, v175
    v_fmac_f32 v19, v175, v175
    v_add_f32 v16, v16, v18
    v_add_f32 v17, v17, v19
    v_mov_b32 v18, v16
    v_mov_b32 v19, v17
    s_nop 0
    v_permlane32_swap_b32 v16, v18
    v_permlane32_swap_b32 v17, v19
    v_add_f32 v16, v16, v18
    v_add_f32 v17, v17, v19
    s_mov_b32 exec_hi, 0
    s_cmp_eq_u32 s97, 0
    s_cbranch_scc1 A_52
    buffer_store_dwordx2 v[16:17], v41, s[76:79], s86 offen
B_53:
    s_mov_b64 exec, -1
    v_cvt_pk_bf16_f32 v104, v160, v161
    v_cvt_pk_bf16_f32 v105, v162, v163
    v_cvt_pk_bf16_f32 v106, v164, v165
    v_cvt_pk_bf16_f32 v107, v166, v167
    v_cvt_pk_bf16_f32 v108, v168, v169
    v_cvt_pk_bf16_f32 v109, v170, v171
    v_cvt_pk_bf16_f32 v110, v172, v173
    v_cvt_pk_bf16_f32 v111, v174, v175
    v_and_b32 v20, 15, v1
    v_lshlrev_b32 v20, s98, v20
    s_add_u32 s15, s68, 2048
    s_lshl_b32 s10, s3, 2
    s_add_u32 s10, s10, s5
    s_lshl_b32 s85, s10, 15
    s_add_u32 s85, s85, 0
    s_lshl_b32 s86, s10, 12
    s_add_u32 s86, s86, 786432
    s_mul_i32 s99, s10, 86
    v_lshl_add_u32 v41, v3, 11, v41
    v_bfe_u32 v21, v1, 2, 2
    v_lshl_add_u32 v21, v3, 3, v21
    v_mul_u32_u24 v21, 192, v21
    v_and_b32 v22, 0x38, v33
    v_add_u32 v21, v21, v22
    v_add_u32 v42, 20480, v21
    v_add_u32 v43, 69632, v21
    s_and_b32 s12, s4, 7
    s_lshr_b32 s13, s4, 3
    s_mul_i32 s82, s13, 43
    s_mul_i32 s13, s12, 5
    s_add_u32 s82, s82, s13
    s_max_u32 s13, s12, 5
    s_sub_u32 s13, s13, 5
    s_add_u32 s82, s82, s13
    s_cmp_ge_u32 s12, 5
    s_cselect_b32 s83, 1, 0
    s_add_u32 s99, s99, s82
    s_lshl_b32 s99, s99, 10
    s_add_u32 s99, s99, 6291456
    s_add_u32 s69, s69, 4096
    ds_read_b32 v6, v4 offset:60
    ds_read_b32 v7, v4 offset:64
    s_waitcnt vmcnt(0)
    s_mov_b64 exec, 1
    s_cmp_eq_u32 s97, 0
    s_cbranch_scc1 A_54
    buffer_store_dword v38, off, s[76:79], s71
B_55:
    s_mov_b64 exec, -1
    s_waitcnt lgkmcnt(1)
    v_cmp_eq_u32 vcc, s96, v6
    s_cbranch_vccnz F_57
F_56:
    ds_read_b32 v6, v4 offset:60
    s_add_u32 s84, s84, 1
    s_waitcnt lgkmcnt(0)
    v_cmp_ne_u32 vcc, s96, v6
    s_cmp_gt_u32 s84, 200000
    s_cbranch_scc1 F_57
    s_cbranch_vccnz F_56
F_57:
    s_waitcnt lgkmcnt(0)
    v_cmp_eq_u32 vcc, s96, v7
    s_cbranch_vccnz F_59
F_58:
    ds_read_b32 v7, v4 offset:64
    s_add_u32 s84, s84, 1
    s_waitcnt lgkmcnt(0)
    v_cmp_ne_u32 vcc, s96, v7
    s_cmp_gt_u32 s84, 200000
    s_cbranch_scc1 F_59
    s_cbranch_vccnz F_58
F_59:
    ds_read_b64_tr_b16 v[24:25], v42 offset:0
    ds_read_b64_tr_b16 v[26:27], v42 offset:768
    ds_read_b64_tr_b16 v[28:29], v42 offset:64
    ds_read_b64_tr_b16 v[30:31], v42 offset:832
    ds_read_b64_tr_b16 v[92:93], v42 offset:128
    ds_read_b64_tr_b16 v[94:95], v42 offset:896
    ds_read_b64_tr_b16 v[96:97], v42 offset:3072
    ds_read_b64_tr_b16 v[98:99], v42 offset:3840
    ds_read_b64_tr_b16 v[100:101], v42 offset:3136
    ds_read_b64_tr_b16 v[102:103], v42 offset:3904
P_60:
    buffer_load_dword v8, v20, s[76:79], s15 offen sc1
    s_add_u32 s84, s84, 8
    s_waitcnt vmcnt(0)
    v_cmp_ne_u32 vcc, s6, v8
    s_cmp_gt_u32 s84, 200000
    s_cbranch_scc1 P_61
    s_cbranch_vccnz P_60
P_61:
    s_mov_b32 s89, s85
    s_add_u32 s88, s89, 0
    buffer_load_dwordx4 v[128:131], v2, s[72:75], s88 offen offset:0 sc1
    buffer_load_dwordx4 v[132:135], v2, s[72:75], s88 offen offset:1024 sc1
    buffer_load_dwordx4 v[136:139], v2, s[72:75], s88 offen offset:2048 sc1
    buffer_load_dwordx4 v[140:143], v2, s[72:75], s88 offen offset:3072 sc1
    s_add_u32 s88, s89, 4096
    buffer_load_dwordx4 v[144:147], v2, s[72:75], s88 offen offset:0 sc1
    buffer_load_dwordx4 v[148:151], v2, s[72:75], s88 offen offset:1024 sc1
    buffer_load_dwordx4 v[152:155], v2, s[72:75], s88 offen offset:2048 sc1
    buffer_load_dwordx4 v[156:159], v2, s[72:75], s88 offen offset:3072 sc1
    s_add_u32 s88, s89, 8192
    buffer_load_dwordx4 v[160:163], v2, s[72:75], s88 offen offset:0 sc1
    buffer_load_dwordx4 v[164:167], v2, s[72:75], s88 offen offset:1024 sc1
    buffer_load_dwordx4 v[168:171], v2, s[72:75], s88 offen offset:2048 sc1
    buffer_load_dwordx4 v[172:175], v2, s[72:75], s88 offen offset:3072 sc1
    s_add_u32 s88, s89, 12288
    buffer_load_dwordx4 v[176:179], v2, s[72:75], s88 offen offset:0 sc1
    buffer_load_dwordx4 v[180:183], v2, s[72:75], s88 offen offset:1024 sc1
    buffer_load_dwordx4 v[184:187], v2, s[72:75], s88 offen offset:2048 sc1
    buffer_load_dwordx4 v[188:191], v2, s[72:75], s88 offen offset:3072 sc1
    buffer_load_dwordx4 v[8:11], v41, s[76:79], s86 offen offset:0 sc1
    buffer_load_dwordx4 v[12:15], v41, s[76:79], s86 offen offset:512 sc1
    buffer_load_dwordx4 v[16:19], v41, s[76:79], s86 offen offset:1024 sc1
    buffer_load_dwordx4 v[20:23], v41, s[76:79], s86 offen offset:1536 sc1
    s_waitcnt vmcnt(19) lgkmcnt(8)
    v_mfma_f32_32x32x16_bf16 v[44:59], v[24:27], v[128:131], 0
    s_add_u32 s88, s89, 16384
    buffer_load_dwordx4 v[192:195], v2, s[72:75], s88 offen offset:0 sc1
    ds_read_b64_tr_b16 v[24:25], v42 offset:3200
    ds_read_b64_tr_b16 v[26:27], v42 offset:3968
    s_waitcnt lgkmcnt(8)
    v_mfma_f32_32x32x16_bf16 v[60:75], v[28:31], v[128:131], 0
    ds_read_b64_tr_b16 v[28:29], v42 offset:6144
    ds_read_b64_tr_b16 v[30:31], v42 offset:6912
    s_waitcnt lgkmcnt(8)
    v_mfma_f32_32x32x16_bf16 v[76:91], v[92:95], v[128:131], 0
    ds_read_b64_tr_b16 v[92:93], v42 offset:6208
    ds_read_b64_tr_b16 v[94:95], v42 offset:6976
    s_waitcnt vmcnt(19) lgkmcnt(8)
    v_mfma_f32_32x32x16_bf16 v[44:59], v[96:99], v[132:135], v[44:59]
    buffer_load_dwordx4 v[196:199], v2, s[72:75], s88 offen offset:1024 sc1
    ds_read_b64_tr_b16 v[96:97], v42 offset:6272
    ds_read_b64_tr_b16 v[98:99], v42 offset:7040
    s_waitcnt lgkmcnt(8)
    v_mfma_f32_32x32x16_bf16 v[60:75], v[100:103], v[132:135], v[60:75]
    ds_read_b64_tr_b16 v[100:101], v42 offset:9216
    ds_read_b64_tr_b16 v[102:103], v42 offset:9984
    s_waitcnt lgkmcnt(8)
    v_mfma_f32_32x32x16_bf16 v[76:91], v[24:27], v[132:135], v[76:91]
    ds_read_b64_tr_b16 v[24:25], v42 offset:9280
    ds_read_b64_tr_b16 v[26:27], v42 offset:10048
    s_waitcnt vmcnt(19) lgkmcnt(8)
    v_mfma_f32_32x32x16_bf16 v[44:59], v[28:31], v[136:139], v[44:59]
    buffer_load_dwordx4 v[200:203], v2, s[72:75], s88 offen offset:2048 sc1
    ds_read_b64_tr_b16 v[28:29], v42 offset:9344
    ds_read_b64_tr_b16 v[30:31], v42 offset:10112
    s_waitcnt lgkmcnt(8)
    v_mfma_f32_32x32x16_bf16 v[60:75], v[92:95], v[136:139], v[60:75]
    ds_read_b64_tr_b16 v[92:93], v42 offset:12288
    ds_read_b64_tr_b16 v[94:95], v42 offset:13056
    s_waitcnt lgkmcnt(8)
    v_mfma_f32_32x32x16_bf16 v[76:91], v[96:99], v[136:139], v[76:91]
    ds_read_b64_tr_b16 v[96:97], v42 offset:12352
    ds_read_b64_tr_b16 v[98:99], v42 offset:13120
    s_waitcnt vmcnt(19) lgkmcnt(8)
    v_mfma_f32_32x32x16_bf16 v[44:59], v[100:103], v[140:143], v[44:59]
    buffer_load_dwordx4 v[204:207], v2, s[72:75], s88 offen offset:3072 sc1
    ds_read_b64_tr_b16 v[100:101], v42 offset:12416
    ds_read_b64_tr_b16 v[102:103], v42 offset:13184
    s_waitcnt lgkmcnt(8)
    v_mfma_f32_32x32x16_bf16 v[60:75], v[24:27], v[140:143], v[60:75]
    ds_read_b64_tr_b16 v[24:25], v42 offset:15360
    ds_read_b64_tr_b16 v[26:27], v42 offset:16128
    s_waitcnt lgkmcnt(8)
    v_mfma_f32_32x32x16_bf16 v[76:91], v[28:31], v[140:143], v[76:91]
    ds_read_b64_tr_b16 v[28:29], v42 offset:15424
    ds_read_b64_tr_b16 v[30:31], v42 offset:16192
    s_waitcnt vmcnt(19) lgkmcnt(8)
    v_mfma_f32_32x32x16_bf16 v[44:59], v[92:95], v[144:147], v[44:59]
    s_add_u32 s88, s89, 20480
    buffer_load_dwordx4 v[208:211], v2, s[72:75], s88 offen offset:0 sc1
    ds_read_b64_tr_b16 v[92:93], v42 offset:15488
    ds_read_b64_tr_b16 v[94:95], v42 offset:16256
    s_waitcnt lgkmcnt(8)
    v_mfma_f32_32x32x16_bf16 v[60:75], v[96:99], v[144:147], v[60:75]
    ds_read_b64_tr_b16 v[96:97], v42 offset:18432
    ds_read_b64_tr_b16 v[98:99], v42 offset:19200
    s_waitcnt lgkmcnt(8)
    v_mfma_f32_32x32x16_bf16 v[76:91], v[100:103], v[144:147], v[76:91]
    ds_read_b64_tr_b16 v[100:101], v42 offset:18496
    ds_read_b64_tr_b16 v[102:103], v42 offset:19264
    s_waitcnt vmcnt(19) lgkmcnt(8)
    v_mfma_f32_32x32x16_bf16 v[44:59], v[24:27], v[148:151], v[44:59]
    buffer_load_dwordx4 v[212:215], v2, s[72:75], s88 offen offset:1024 sc1
    ds_read_b64_tr_b16 v[24:25], v42 offset:18560
    ds_read_b64_tr_b16 v[26:27], v42 offset:19328
    s_waitcnt lgkmcnt(8)
    v_mfma_f32_32x32x16_bf16 v[60:75], v[28:31], v[148:151], v[60:75]
    ds_read_b64_tr_b16 v[28:29], v42 offset:21504
    ds_read_b64_tr_b16 v[30:31], v42 offset:22272
    s_waitcnt lgkmcnt(8)
    v_mfma_f32_32x32x16_bf16 v[76:91], v[92:95], v[148:151], v[76:91]
    ds_read_b64_tr_b16 v[92:93], v42 offset:21568
    ds_read_b64_tr_b16 v[94:95], v42 offset:22336
    s_waitcnt vmcnt(19) lgkmcnt(8)
    v_mfma_f32_32x32x16_bf16 v[44:59], v[96:99], v[152:155], v[44:59]
    buffer_load_dwordx4 v[216:219], v2, s[72:75], s88 offen offset:2048 sc1
    ds_read_b64_tr_b16 v[96:97], v42 offset:21632
    ds_read_b64_tr_b16 v[98:99], v42 offset:22400
    s_waitcnt lgkmcnt(8)
    v_mfma_f32_32x32x16_bf16 v[60:75], v[100:103], v[152:155], v[60:75]
    ds_read_b64_tr_b16 v[100:101], v42 offset:24576
    ds_read_b64_tr_b16 v[102:103], v42 offset:25344
    s_waitcnt lgkmcnt(8)
    v_mfma_f32_32x32x16_bf16 v[76:91], v[24:27], v[152:155], v[76:91]
    ds_read_b64_tr_b16 v[24:25], v42 offset:24640
    ds_read_b64_tr_b16 v[26:27], v42 offset:25408
    s_waitcnt vmcnt(19) lgkmcnt(8)
    v_mfma_f32_32x32x16_bf16 v[44:59], v[28:31], v[156:159], v[44:59]
    buffer_load_dwordx4 v[220:223], v2, s[72:75], s88 offen offset:3072 sc1
    ds_read_b64_tr_b16 v[28:29], v42 offset:24704
    ds_read_b64_tr_b16 v[30:31], v42 offset:25472
    s_waitcnt lgkmcnt(8)
    v_mfma_f32_32x32x16_bf16 v[60:75], v[92:95], v[156:159], v[60:75]
    ds_read_b64_tr_b16 v[92:93], v42 offset:27648
    ds_read_b64_tr_b16 v[94:95], v42 offset:28416
    s_waitcnt lgkmcnt(8)
    v_mfma_f32_32x32x16_bf16 v[76:91], v[96:99], v[156:159], v[76:91]
    ds_read_b64_tr_b16 v[96:97], v42 offset:27712
    ds_read_b64_tr_b16 v[98:99], v42 offset:28480
    s_waitcnt vmcnt(19) lgkmcnt(8)
    v_mfma_f32_32x32x16_bf16 v[44:59], v[100:103], v[160:163], v[44:59]
    s_add_u32 s88, s89, 24576
    buffer_load_dwordx4 v[224:227], v2, s[72:75], s88 offen offset:0 sc1
    ds_read_b64_tr_b16 v[100:101], v42 offset:27776
    ds_read_b64_tr_b16 v[102:103], v42 offset:28544
    s_waitcnt lgkmcnt(8)
    v_mfma_f32_32x32x16_bf16 v[60:75], v[24:27], v[160:163], v[60:75]
    ds_read_b64_tr_b16 v[24:25], v42 offset:30720
    ds_read_b64_tr_b16 v[26:27], v42 offset:31488
    s_waitcnt lgkmcnt(8)
    v_mfma_f32_32x32x16_bf16 v[76:91], v[28:31], v[160:163], v[76:91]
    ds_read_b64_tr_b16 v[28:29], v42 offset:30784
    ds_read_b64_tr_b16 v[30:31], v42 offset:31552
    s_waitcnt vmcnt(19) lgkmcnt(8)
    v_mfma_f32_32x32x16_bf16 v[44:59], v[92:95], v[164:167], v[44:59]
    buffer_load_dwordx4 v[228:231], v2, s[72:75], s88 offen offset:1024 sc1
    ds_read_b64_tr_b16 v[92:93], v42 offset:30848
    ds_read_b64_tr_b16 v[94:95], v42 offset:31616
    s_waitcnt lgkmcnt(8)
    v_mfma_f32_32x32x16_bf16 v[60:75], v[96:99], v[164:167], v[60:75]
    ds_read_b64_tr_b16 v[96:97], v42 offset:33792
    ds_read_b64_tr_b16 v[98:99], v42 offset:34560
    s_waitcnt lgkmcnt(8)
    v_mfma_f32_32x32x16_bf16 v[76:91], v[100:103], v[164:167], v[76:91]
    ds_read_b64_tr_b16 v[100:101], v42 offset:33856
    ds_read_b64_tr_b16 v[102:103], v42 offset:34624
    s_waitcnt vmcnt(19) lgkmcnt(8)
    v_mfma_f32_32x32x16_bf16 v[44:59], v[24:27], v[168:171], v[44:59]
    buffer_load_dwordx4 v[232:235], v2, s[72:75], s88 offen offset:2048 sc1
    ds_read_b64_tr_b16 v[24:25], v42 offset:33920
    ds_read_b64_tr_b16 v[26:27], v42 offset:34688
    s_waitcnt lgkmcnt(8)
    v_mfma_f32_32x32x16_bf16 v[60:75], v[28:31], v[168:171], v[60:75]
    ds_read_b64_tr_b16 v[28:29], v42 offset:36864
    ds_read_b64_tr_b16 v[30:31], v42 offset:37632
    s_waitcnt lgkmcnt(8)
    v_mfma_f32_32x32x16_bf16 v[76:91], v[92:95], v[168:171], v[76:91]
    ds_read_b64_tr_b16 v[92:93], v42 offset:36928
    ds_read_b64_tr_b16 v[94:95], v42 offset:37696
    s_waitcnt vmcnt(19) lgkmcnt(8)
    v_mfma_f32_32x32x16_bf16 v[44:59], v[96:99], v[172:175], v[44:59]
    buffer_load_dwordx4 v[236:239], v2, s[72:75], s88 offen offset:3072 sc1
    ds_read_b64_tr_b16 v[96:97], v42 offset:36992
    ds_read_b64_tr_b16 v[98:99], v42 offset:37760
    s_waitcnt lgkmcnt(8)
    v_mfma_f32_32x32x16_bf16 v[60:75], v[100:103], v[172:175], v[60:75]
    ds_read_b64_tr_b16 v[100:101], v42 offset:39936
    ds_read_b64_tr_b16 v[102:103], v42 offset:40704
    s_waitcnt lgkmcnt(8)
    v_mfma_f32_32x32x16_bf16 v[76:91], v[24:27], v[172:175], v[76:91]
    ds_read_b64_tr_b16 v[24:25], v42 offset:40000
    ds_read_b64_tr_b16 v[26:27], v42 offset:40768
    s_waitcnt vmcnt(19) lgkmcnt(8)
    v_mfma_f32_32x32x16_bf16 v[44:59], v[28:31], v[176:179], v[44:59]
    s_add_u32 s88, s89, 28672
    buffer_load_dwordx4 v[240:243], v2, s[72:75], s88 offen offset:0 sc1
    ds_read_b64_tr_b16 v[28:29], v42 offset:40064
    ds_read_b64_tr_b16 v[30:31], v42 offset:40832
    s_waitcnt lgkmcnt(8)
    v_mfma_f32_32x32x16_bf16 v[60:75], v[92:95], v[176:179], v[60:75]
    ds_read_b64_tr_b16 v[92:93], v42 offset:43008
    ds_read_b64_tr_b16 v[94:95], v42 offset:43776
    s_waitcnt lgkmcnt(8)
    v_mfma_f32_32x32x16_bf16 v[76:91], v[96:99], v[176:179], v[76:91]
    ds_read_b64_tr_b16 v[96:97], v42 offset:43072
    ds_read_b64_tr_b16 v[98:99], v42 offset:43840
    s_waitcnt vmcnt(19) lgkmcnt(8)
    v_mfma_f32_32x32x16_bf16 v[44:59], v[100:103], v[180:183], v[44:59]
    buffer_load_dwordx4 v[244:247], v2, s[72:75], s88 offen offset:1024 sc1
    ds_read_b64_tr_b16 v[100:101], v42 offset:43136
    ds_read_b64_tr_b16 v[102:103], v42 offset:43904
    s_waitcnt lgkmcnt(8)
    v_mfma_f32_32x32x16_bf16 v[60:75], v[24:27], v[180:183], v[60:75]
    ds_read_b64_tr_b16 v[24:25], v42 offset:46080
    ds_read_b64_tr_b16 v[26:27], v42 offset:46848
    s_waitcnt lgkmcnt(8)
    v_mfma_f32_32x32x16_bf16 v[76:91], v[28:31], v[180:183], v[76:91]
    ds_read_b64_tr_b16 v[28:29], v42 offset:46144
    ds_read_b64_tr_b16 v[30:31], v42 offset:46912
    s_waitcnt vmcnt(19) lgkmcnt(8)
    v_mfma_f32_32x32x16_bf16 v[44:59], v[92:95], v[184:187], v[44:59]
    buffer_load_dwordx4 v[248:251], v2, s[72:75], s88 offen offset:2048 sc1
    ds_read_b64_tr_b16 v[92:93], v42 offset:46208
    ds_read_b64_tr_b16 v[94:95], v42 offset:46976
    s_waitcnt lgkmcnt(8)
    v_mfma_f32_32x32x16_bf16 v[60:75], v[96:99], v[184:187], v[60:75]
    ds_read_b64_tr_b16 v[96:97], v43 offset:0
    ds_read_b64_tr_b16 v[98:99], v43 offset:768
    s_waitcnt lgkmcnt(8)
    v_mfma_f32_32x32x16_bf16 v[76:91], v[100:103], v[184:187], v[76:91]
    ds_read_b64_tr_b16 v[100:101], v43 offset:64
    ds_read_b64_tr_b16 v[102:103], v43 offset:832
    s_waitcnt vmcnt(19) lgkmcnt(8)
    v_mfma_f32_32x32x16_bf16 v[44:59], v[24:27], v[188:191], v[44:59]
    buffer_load_dwordx4 v[252:255], v2, s[72:75], s88 offen offset:3072 sc1
    s_mov_b64 exec, 1
    ds_write_b8 v0, v5 offset:116
    s_mov_b64 exec, -1
    ds_read_b32 v6, v4 offset:68
    ds_read_b64_tr_b16 v[24:25], v43 offset:128
    ds_read_b64_tr_b16 v[26:27], v43 offset:896
    s_waitcnt lgkmcnt(10)
    v_mfma_f32_32x32x16_bf16 v[60:75], v[28:31], v[188:191], v[60:75]
    ds_read_b64_tr_b16 v[28:29], v43 offset:3072
    ds_read_b64_tr_b16 v[30:31], v43 offset:3840
    s_waitcnt lgkmcnt(10)
    v_mfma_f32_32x32x16_bf16 v[76:91], v[92:95], v[188:191], v[76:91]
    ds_read_b64_tr_b16 v[92:93], v43 offset:3136
    ds_read_b64_tr_b16 v[94:95], v43 offset:3904
    s_waitcnt vmcnt(15) lgkmcnt(10)
    v_mfma_f32_32x32x16_bf16 v[44:59], v[96:99], v[192:195], v[44:59]
    ds_read_b64_tr_b16 v[96:97], v43 offset:3200
    ds_read_b64_tr_b16 v[98:99], v43 offset:3968
    s_waitcnt lgkmcnt(10)
    v_mfma_f32_32x32x16_bf16 v[60:75], v[100:103], v[192:195], v[60:75]
    ds_read_b64_tr_b16 v[100:101], v43 offset:6144
    ds_read_b64_tr_b16 v[102:103], v43 offset:6912
    s_waitcnt lgkmcnt(8)
    v_mfma_f32_32x32x16_bf16 v[76:91], v[24:27], v[192:195], v[76:91]
    v_cmp_eq_u32 vcc, s96, v6
    s_cbranch_vccnz F_63
F_62:
    ds_read_b32 v6, v4 offset:68
    s_add_u32 s84, s84, 1
    s_waitcnt lgkmcnt(0)
    v_cmp_ne_u32 vcc, s96, v6
    s_cmp_gt_u32 s84, 200000
    s_cbranch_scc1 F_63
    s_cbranch_vccnz F_62
F_63:
    ds_read_b64_tr_b16 v[24:25], v43 offset:6208
    ds_read_b64_tr_b16 v[26:27], v43 offset:6976
    s_waitcnt vmcnt(14) lgkmcnt(8)
    v_mfma_f32_32x32x16_bf16 v[44:59], v[28:31], v[196:199], v[44:59]
    ds_read_b64_tr_b16 v[28:29], v43 offset:6272
    ds_read_b64_tr_b16 v[30:31], v43 offset:7040
    s_waitcnt lgkmcnt(8)
    v_mfma_f32_32x32x16_bf16 v[60:75], v[92:95], v[196:199], v[60:75]
    ds_read_b64_tr_b16 v[92:93], v43 offset:9216
    ds_read_b64_tr_b16 v[94:95], v43 offset:9984
    s_waitcnt lgkmcnt(8)
    v_mfma_f32_32x32x16_bf16 v[76:91], v[96:99], v[196:199], v[76:91]
    ds_read_b64_tr_b16 v[96:97], v43 offset:9280
    ds_read_b64_tr_b16 v[98:99], v43 offset:10048
    s_waitcnt vmcnt(13) lgkmcnt(8)
    v_mfma_f32_32x32x16_bf16 v[44:59], v[100:103], v[200:203], v[44:59]
    ds_read_b64_tr_b16 v[100:101], v43 offset:9344
    ds_read_b64_tr_b16 v[102:103], v43 offset:10112
    v_add_f32 v8, v8, v10
    v_add_f32 v9, v9, v11
    s_waitcnt lgkmcnt(8)
    v_mfma_f32_32x32x16_bf16 v[60:75], v[24:27], v[200:203], v[60:75]
    ds_read_b64_tr_b16 v[24:25], v43 offset:12288
    ds_read_b64_tr_b16 v[26:27], v43 offset:13056
    v_add_f32 v8, v8, v12
    v_add_f32 v9, v9, v13
    s_waitcnt lgkmcnt(8)
    v_mfma_f32_32x32x16_bf16 v[76:91], v[28:31], v[200:203], v[76:91]
    ds_read_b64_tr_b16 v[28:29], v43 offset:12352
    ds_read_b64_tr_b16 v[30:31], v43 offset:13120
    v_add_f32 v8, v8, v14
    v_add_f32 v9, v9, v15
    s_waitcnt vmcnt(12) lgkmcnt(8)
    v_mfma_f32_32x32x16_bf16 v[44:59], v[92:95], v[204:207], v[44:59]
    ds_read_b64_tr_b16 v[92:93], v43 offset:12416
    ds_read_b64_tr_b16 v[94:95], v43 offset:13184
    v_add_f32 v8, v8, v16
    v_add_f32 v9, v9, v17
    v_add_f32 v8, v8, v18
    s_waitcnt lgkmcnt(8)
    v_mfma_f32_32x32x16_bf16 v[60:75], v[96:99], v[204:207], v[60:75]
    ds_read_b64_tr_b16 v[96:97], v43 offset:15360
    ds_read_b64_tr_b16 v[98:99], v43 offset:16128
    v_add_f32 v9, v9, v19
    v_add_f32 v8, v8, v20
    s_waitcnt lgkmcnt(8)
    v_mfma_f32_32x32x16_bf16 v[76:91], v[100:103], v[204:207], v[76:91]
    ds_read_b64_tr_b16 v[100:101], v43 offset:15424
    ds_read_b64_tr_b16 v[102:103], v43 offset:16192
    v_add_f32 v9, v9, v21
    v_add_f32 v8, v8, v22
    s_waitcnt vmcnt(11) lgkmcnt(8)
    v_mfma_f32_32x32x16_bf16 v[44:59], v[24:27], v[208:211], v[44:59]
    ds_read_b64_tr_b16 v[24:25], v43 offset:15488
    ds_read_b64_tr_b16 v[26:27], v43 offset:16256
    v_add_f32 v9, v9, v23
    v_mov_b32 v10, v8
    v_mov_b32 v11, v9
    s_waitcnt lgkmcnt(8)
    v_mfma_f32_32x32x16_bf16 v[60:75], v[28:31], v[208:211], v[60:75]
    ds_read_b64_tr_b16 v[28:29], v43 offset:18432
    ds_read_b64_tr_b16 v[30:31], v43 offset:19200
    v_permlane32_swap_b32 v8, v10
    v_permlane32_swap_b32 v9, v11
    s_waitcnt lgkmcnt(8)
    v_mfma_f32_32x32x16_bf16 v[76:91], v[92:95], v[208:211], v[76:91]
    ds_read_b64_tr_b16 v[92:93], v43 offset:18496
    ds_read_b64_tr_b16 v[94:95], v43 offset:19264
    v_add_f32 v8, v8, v10
    v_add_f32 v9, v9, v11
    s_waitcnt vmcnt(10) lgkmcnt(8)
    v_mfma_f32_32x32x16_bf16 v[44:59], v[96:99], v[212:215], v[44:59]
    ds_read_b64_tr_b16 v[96:97], v43 offset:18560
    ds_read_b64_tr_b16 v[98:99], v43 offset:19328
    v_mul_f32 v8, 0xbb000000, v8
    v_mul_f32 v10, v8, v8
    s_waitcnt lgkmcnt(8)
    v_mfma_f32_32x32x16_bf16 v[60:75], v[100:103], v[212:215], v[60:75]
    ds_read_b64_tr_b16 v[100:101], v43 offset:21504
    ds_read_b64_tr_b16 v[102:103], v43 offset:22272
    v_mov_b32 v11, 0x3b000000
    v_fma_f32 v9, v9, v11, -v10
    v_max_f32 v9, 0, v9
    s_waitcnt lgkmcnt(8)
    v_mfma_f32_32x32x16_bf16 v[76:91], v[24:27], v[212:215], v[76:91]
    ds_read_b64_tr_b16 v[24:25], v43 offset:21568
    ds_read_b64_tr_b16 v[26:27], v43 offset:22336
    v_add_f32 v9, 0x3727c5ac, v9
    v_rsq_f32 v12, v9
    s_waitcnt vmcnt(9) lgkmcnt(8)
    v_mfma_f32_32x32x16_bf16 v[44:59], v[28:31], v[216:219], v[44:59]
    ds_read_b64_tr_b16 v[28:29], v43 offset:21632
    ds_read_b64_tr_b16 v[30:31], v43 offset:22400
    v_mul_f32 v9, v9, v12
    v_cvt_pk_bf16_f32 v113, v9, v9
    s_waitcnt lgkmcnt(8)
    v_mfma_f32_32x32x16_bf16 v[60:75], v[92:95], v[216:219], v[60:75]
    ds_read_b64_tr_b16 v[92:93], v43 offset:24576
    ds_read_b64_tr_b16 v[94:95], v43 offset:25344
    v_and_b32 v10, 0xffff0000, v113
    v_sub_f32 v10, v9, v10
    v_cvt_pk_bf16_f32 v112, v8, v10
    s_waitcnt lgkmcnt(8)
    v_mfma_f32_32x32x16_bf16 v[76:91], v[96:99], v[216:219], v[76:91]
    ds_read_b64_tr_b16 v[96:97], v43 offset:24640
    ds_read_b64_tr_b16 v[98:99], v43 offset:25408
    v_mov_b32 v115, v113
    v_mov_b32 v114, v112
    s_waitcnt vmcnt(8) lgkmcnt(8)
    v_mfma_f32_32x32x16_bf16 v[44:59], v[100:103], v[220:223], v[44:59]
    ds_read_b64_tr_b16 v[100:101], v43 offset:24704
    ds_read_b64_tr_b16 v[102:103], v43 offset:25472
    v_lshrrev_b32 v13, 2, v2
    v_and_b32 v13, 0x7c, v13
    s_waitcnt lgkmcnt(8)
    v_mfma_f32_32x32x16_bf16 v[60:75], v[24:27], v[220:223], v[60:75]
    ds_read_b64_tr_b16 v[24:25], v43 offset:27648
    ds_read_b64_tr_b16 v[26:27], v43 offset:28416
    s_lshl_b32 s11, s5, 7
    v_add_u32 v13, s11, v13
    s_waitcnt lgkmcnt(8)
    v_mfma_f32_32x32x16_bf16 v[76:91], v[28:31], v[220:223], v[76:91]
    ds_read_b64_tr_b16 v[28:29], v43 offset:27712
    ds_read_b64_tr_b16 v[30:31], v43 offset:28480
    ds_write_b32 v13, v12 offset:128
    s_and_b32 s14, s5, 1
    s_mul_i32 s11, s14, 49152
    s_waitcnt vmcnt(7) lgkmcnt(9)
    v_mfma_f32_32x32x16_bf16 v[44:59], v[92:95], v[224:227], v[44:59]
    ds_read_b64_tr_b16 v[92:93], v43 offset:27776
    ds_read_b64_tr_b16 v[94:95], v43 offset:28544
    s_add_u32 s11, s11, 20480
    v_add_u32 v116, s11, v33
    s_waitcnt lgkmcnt(9)
    v_mfma_f32_32x32x16_bf16 v[60:75], v[96:99], v[224:227], v[60:75]
    ds_read_b64_tr_b16 v[96:97], v43 offset:30720
    ds_read_b64_tr_b16 v[98:99], v43 offset:31488
    v_add_u32 v117, s11, v37
    s_mul_i32 s11, s14, 22528
    s_waitcnt lgkmcnt(9)
    v_mfma_f32_32x32x16_bf16 v[76:91], v[100:103], v[224:227], v[76:91]
    ds_read_b64_tr_b16 v[100:101], v43 offset:30784
    ds_read_b64_tr_b16 v[102:103], v43 offset:31552
    s_add_u32 s11, s11, 118784
    v_add_u32 v33, s11, v33
    v_add_u32 v37, s11, v37
    s_waitcnt vmcnt(6) lgkmcnt(9)
    v_mfma_f32_32x32x16_bf16 v[44:59], v[24:27], v[228:231], v[44:59]
    ds_read_b64_tr_b16 v[24:25], v43 offset:30848
    ds_read_b64_tr_b16 v[26:27], v43 offset:31616
    s_mul_i32 s85, s87, 86
    s_mul_i32 s11, s14, 43
    s_waitcnt lgkmcnt(9)
    v_mfma_f32_32x32x16_bf16 v[60:75], v[28:31], v[228:231], v[60:75]
    ds_read_b64_tr_b16 v[28:29], v43 offset:33792
    ds_read_b64_tr_b16 v[30:31], v43 offset:34560
    s_add_u32 s85, s85, s11
    s_lshl_b32 s85, s85, 10
    s_waitcnt lgkmcnt(8)
    v_mfma_f32_32x32x16_bf16 v[76:91], v[92:95], v[228:231], v[76:91]
    ds_read_b64_tr_b16 v[92:93], v43 offset:33856
    ds_read_b64_tr_b16 v[94:95], v43 offset:34624
    s_add_u32 s85, s85, 6291456
    s_add_u32 s70, s70, 4096
    s_waitcnt vmcnt(5) lgkmcnt(8)
    v_mfma_f32_32x32x16_bf16 v[44:59], v[96:99], v[232:235], v[44:59]
    ds_read_b64_tr_b16 v[96:97], v43 offset:33920
    ds_read_b64_tr_b16 v[98:99], v43 offset:34688
    s_and_b32 s11, s87, 3
    s_lshl_b32 s11, s11, 7
    v_and_b32 v13, 0x7c, v13
    s_waitcnt lgkmcnt(8)
    v_mfma_f32_32x32x16_bf16 v[60:75], v[100:103], v[232:235], v[60:75]
    ds_read_b64_tr_b16 v[100:101], v43 offset:36864
    ds_read_b64_tr_b16 v[102:103], v43 offset:37632
    v_add_u32 v41, s11, v13
    s_and_b32 s12, s3, 1
    s_waitcnt lgkmcnt(8)
    v_mfma_f32_32x32x16_bf16 v[76:91], v[24:27], v[232:235], v[76:91]
    ds_read_b64_tr_b16 v[24:25], v43 offset:36928
    ds_read_b64_tr_b16 v[26:27], v43 offset:37696
    s_lshl_b32 s12, s12, 1
    s_lshr_b32 s13, s4, 3
    s_waitcnt vmcnt(4) lgkmcnt(8)
    v_mfma_f32_32x32x16_bf16 v[44:59], v[28:31], v[236:239], v[44:59]
    ds_read_b64_tr_b16 v[28:29], v43 offset:36992
    ds_read_b64_tr_b16 v[30:31], v43 offset:37760
    s_add_u32 s12, s12, s13
    s_mul_i32 s13, s12, 11264
    s_add_u32 s64, s85, s13
    s_waitcnt lgkmcnt(8)
    v_mfma_f32_32x32x16_bf16 v[60:75], v[92:95], v[236:239], v[60:75]
    ds_read_b64_tr_b16 v[92:93], v43 offset:39936
    ds_read_b64_tr_b16 v[94:95], v43 offset:40704
    s_sub_u32 s13, s64, 44032
    s_cmp_ge_u32 s12, 3
    s_waitcnt lgkmcnt(8)
    v_mfma_f32_32x32x16_bf16 v[76:91], v[96:99], v[236:239], v[76:91]
    ds_read_b64_tr_b16 v[96:97], v43 offset:43008
    ds_read_b64_tr_b16 v[98:99], v43 offset:43776
    s_cselect_b32 s65, s13, s64
    s_cmp_ge_u32 s12, 2
    s_waitcnt vmcnt(3) lgkmcnt(8)
    v_mfma_f32_32x32x16_bf16 v[44:59], v[100:103], v[240:243], v[44:59]
    ds_read_b64_tr_b16 v[100:101], v43 offset:46080
    ds_read_b64_tr_b16 v[102:103], v43 offset:46848
    s_cselect_b32 s66, s13, s64
    s_cmp_ge_u32 s12, 1
    s_cselect_b32 s67, s13, s64
    s_waitcnt lgkmcnt(8)
    v_mfma_f32_32x32x16_bf16 v[60:75], v[24:27], v[240:243], v[60:75]
    ds_read_b128 v[24:27], v2 offset:1024
    s_waitcnt lgkmcnt(7)
    v_mfma_f32_32x32x16_bf16 v[76:91], v[28:31], v[240:243], v[76:91]
    ds_read_b64_tr_b16 v[28:29], v43 offset:40000
    ds_read_b64_tr_b16 v[30:31], v43 offset:40768
    s_waitcnt vmcnt(2) lgkmcnt(7)
    v_mfma_f32_32x32x16_bf16 v[44:59], v[92:95], v[244:247], v[44:59]
    ds_read_b64_tr_b16 v[92:93], v43 offset:43072
    ds_read_b64_tr_b16 v[94:95], v43 offset:43840
    s_waitcnt vmcnt(1) lgkmcnt(7)
    v_mfma_f32_32x32x16_bf16 v[44:59], v[96:99], v[248:251], v[44:59]
    ds_read_b64_tr_b16 v[96:97], v43 offset:46144
    ds_read_b64_tr_b16 v[98:99], v43 offset:46912
    s_waitcnt vmcnt(0) lgkmcnt(7)
    v_mfma_f32_32x32x16_bf16 v[44:59], v[100:103], v[252:255], v[44:59]
    ds_read_b128 v[100:103], v2 offset:2048
    s_waitcnt lgkmcnt(7)
    v_mfma_f32_32x32x16_bf16 v[44:59], v[24:27], v[112:115], v[44:59]
    ds_read_b64_tr_b16 v[24:25], v43 offset:40064
    ds_read_b64_tr_b16 v[26:27], v43 offset:40832
    s_waitcnt lgkmcnt(7)
    v_mfma_f32_32x32x16_bf16 v[60:75], v[28:31], v[244:247], v[60:75]
    ds_read_b64_tr_b16 v[28:29], v43 offset:43136
    ds_read_b64_tr_b16 v[30:31], v43 offset:43904
    s_waitcnt lgkmcnt(7)
    v_mfma_f32_32x32x16_bf16 v[60:75], v[92:95], v[248:251], v[60:75]
    ds_read_b64_tr_b16 v[92:93], v43 offset:46208
    ds_read_b64_tr_b16 v[94:95], v43 offset:46976
    s_nop 1
    v_cvt_pk_bf16_f32 v128, v44, v45
    v_pk_max_i16 v128, v128, 0
    v_cvt_pk_bf16_f32 v129, v46, v47
    v_pk_max_i16 v129, v129, 0
    s_waitcnt lgkmcnt(7)
    v_mfma_f32_32x32x16_bf16 v[60:75], v[96:99], v[252:255], v[60:75]
    ds_read_b128 v[96:99], v2 offset:3072
    s_mov_b64 exec, 1
    ds_write_b8 v0, v5 offset:76
    s_mov_b64 exec, -1
    ds_read_b32 v6, v4 offset:72
    v_cvt_pk_bf16_f32 v130, v48, v49
    v_pk_max_i16 v130, v130, 0
    v_cvt_pk_bf16_f32 v131, v50, v51
    v_pk_max_i16 v131, v131, 0
    s_waitcnt lgkmcnt(9)
    v_mfma_f32_32x32x16_bf16 v[60:75], v[100:103], v[112:115], v[60:75]
    v_cvt_pk_bf16_f32 v132, v52, v53
    v_pk_max_i16 v132, v132, 0
    v_cvt_pk_bf16_f32 v133, v54, v55
    v_pk_max_i16 v133, v133, 0
    s_waitcnt lgkmcnt(7)
    v_mfma_f32_32x32x16_bf16 v[76:91], v[24:27], v[244:247], v[76:91]
    v_cvt_pk_bf16_f32 v134, v56, v57
    v_pk_max_i16 v134, v134, 0
    v_cvt_pk_bf16_f32 v135, v58, v59
    v_pk_max_i16 v135, v135, 0
    s_cmp_eq_u32 s97, 0
    s_cbranch_scc1 A_64
    buffer_store_dwordx4 v[128:131], v2, s[76:79], s99 offen offset:0
    buffer_store_dwordx4 v[132:135], v2, s[76:79], s99 offen offset:1024
B_65:
    s_waitcnt lgkmcnt(5)
    v_mfma_f32_32x32x16_bf16 v[76:91], v[28:31], v[248:251], v[76:91]
    v_cvt_pk_bf16_f32 v136, v60, v61
    v_pk_max_i16 v136, v136, 0
    v_cvt_pk_bf16_f32 v137, v62, v63
    v_pk_max_i16 v137, v137, 0
    v_cvt_pk_bf16_f32 v138, v64, v65
    s_waitcnt lgkmcnt(3)
    v_mfma_f32_32x32x16_bf16 v[76:91], v[92:95], v[252:255], v[76:91]
    v_pk_max_i16 v138, v138, 0
    v_cvt_pk_bf16_f32 v139, v66, v67
    v_pk_max_i16 v139, v139, 0
    v_cvt_pk_bf16_f32 v140, v68, v69
    v_pk_max_i16 v140, v140, 0
    s_waitcnt lgkmcnt(2)
    v_mfma_f32_32x32x16_bf16 v[76:91], v[96:99], v[112:115], v[76:91]
    v_cvt_pk_bf16_f32 v141, v70, v71
    v_pk_max_i16 v141, v141, 0
    v_cvt_pk_bf16_f32 v142, v72, v73
    v_pk_max_i16 v142, v142, 0
    v_cvt_pk_bf16_f32 v143, v74, v75
    v_pk_max_i16 v143, v143, 0
    s_cmp_eq_u32 s97, 0
    s_cbranch_scc1 A_66
    buffer_store_dwordx4 v[136:139], v2, s[76:79], s99 offen offset:2048
    buffer_store_dwordx4 v[140:143], v2, s[76:79], s99 offen offset:3072
B_67:
    s_nop 1
    v_cvt_pk_bf16_f32 v144, v76, v77
    v_pk_max_i16 v144, v144, 0
    v_cvt_pk_bf16_f32 v145, v78, v79
    v_pk_max_i16 v145, v145, 0
    v_cvt_pk_bf16_f32 v146, v80, v81
    v_pk_max_i16 v146, v146, 0
    v_cvt_pk_bf16_f32 v147, v82, v83
    v_pk_max_i16 v147, v147, 0
    v_cvt_pk_bf16_f32 v148, v84, v85
    v_pk_max_i16 v148, v148, 0
    v_cvt_pk_bf16_f32 v149, v86, v87
    v_pk_max_i16 v149, v149, 0
    v_cvt_pk_bf16_f32 v150, v88, v89
    v_pk_max_i16 v150, v150, 0
    v_cvt_pk_bf16_f32 v151, v90, v91
    v_pk_max_i16 v151, v151, 0
    s_add_u32 s99, s99, 4096
    s_cmp_eq_u32 s97, 0
    s_cbranch_scc1 A_68
    buffer_store_dwordx4 v[144:147], v2, s[76:79], s99 offen offset:0
B_69:
    s_cmp_eq_u32 s83, 0
    s_cbranch_scc1 L_70
    s_cmp_eq_u32 s97, 0
    s_cbranch_scc1 A_71
    buffer_store_dwordx4 v[148:151], v2, s[76:79], s99 offen offset:1024
B_72:
L_70:
    s_waitcnt lgkmcnt(0)
    v_cmp_eq_u32 vcc, s96, v6
    s_cbranch_vccnz F_74
F_73:
    ds_read_b32 v6, v4 offset:72
    s_add_u32 s84, s84, 1
    s_waitcnt lgkmcnt(0)
    v_cmp_ne_u32 vcc, s96, v6
    s_cmp_gt_u32 s84, 200000
    s_cbranch_scc1 F_74
    s_cbranch_vccnz F_73
F_74:
    ds_read_b64_tr_b16 v[192:193], v33 offset:0
    ds_read_b64_tr_b16 v[194:195], v33 offset:512
    ds_read_b64_tr_b16 v[196:197], v37 offset:0
    ds_read_b64_tr_b16 v[198:199], v37 offset:512
    ds_read_b64_tr_b16 v[200:201], v33 offset:2048
    ds_read_b64_tr_b16 v[202:203], v33 offset:2560
    ds_read_b64_tr_b16 v[204:205], v37 offset:2048
    ds_read_b64_tr_b16 v[206:207], v37 offset:2560
    ds_read_b64_tr_b16 v[208:209], v33 offset:4096
    ds_read_b64_tr_b16 v[210:211], v33 offset:4608
    ds_read_b64_tr_b16 v[212:213], v37 offset:4096
    ds_read_b64_tr_b16 v[214:215], v37 offset:4608
    ds_read_b64_tr_b16 v[216:217], v33 offset:6144
    ds_read_b64_tr_b16 v[218:219], v33 offset:6656
    ds_read_b64_tr_b16 v[220:221], v37 offset:6144
    ds_read_b64_tr_b16 v[222:223], v37 offset:6656
    ds_read_b64_tr_b16 v[224:225], v33 offset:8192
    ds_read_b64_tr_b16 v[226:227], v33 offset:8704
    ds_read_b64_tr_b16 v[228:229], v37 offset:8192
    ds_read_b64_tr_b16 v[230:231], v37 offset:8704
    ds_read_b64_tr_b16 v[232:233], v33 offset:10240
    ds_read_b64_tr_b16 v[234:235], v33 offset:10752
    ds_read_b64_tr_b16 v[236:237], v37 offset:10240
    ds_read_b64_tr_b16 v[238:239], v37 offset:10752
    ds_read_b64_tr_b16 v[240:241], v33 offset:12288
    ds_read_b64_tr_b16 v[242:243], v33 offset:12800
    ds_read_b64_tr_b16 v[244:245], v37 offset:12288
    ds_read_b64_tr_b16 v[246:247], v37 offset:12800
    ds_read_b64_tr_b16 v[248:249], v33 offset:14336
    ds_read_b64_tr_b16 v[250:251], v33 offset:14848
    ds_read_b64_tr_b16 v[252:253], v37 offset:14336
    ds_read_b64_tr_b16 v[254:255], v37 offset:14848
    s_mov_b64 exec, 1
    ds_write_b8 v0, v5 offset:80
    s_mov_b64 exec, -1
    ds_read_b64_tr_b16 v[8:9], v33 offset:16384
    ds_read_b64_tr_b16 v[10:11], v33 offset:16896
    ds_read_b64_tr_b16 v[12:13], v37 offset:16384
    ds_read_b64_tr_b16 v[14:15], v37 offset:16896
    ds_read_b64_tr_b16 v[16:17], v33 offset:18432
    ds_read_b64_tr_b16 v[18:19], v33 offset:18944
    ds_read_b64_tr_b16 v[20:21], v37 offset:18432
    ds_read_b64_tr_b16 v[22:23], v37 offset:18944
    ds_read_b64_tr_b16 v[24:25], v33 offset:20480
    ds_read_b64_tr_b16 v[26:27], v33 offset:20992
    ds_read_b64_tr_b16 v[28:29], v37 offset:20480
    ds_read_b64_tr_b16 v[30:31], v37 offset:20992
    s_waitcnt vmcnt(0)
    s_mov_b64 exec, 1
    s_cmp_eq_u32 s97, 0
    s_cbranch_scc1 A_75
    buffer_store_dword v38, off, s[76:79], s69
B_76:
    s_mov_b64 exec, -1
P_77:
    buffer_load_dword v7, v32, s[76:79], s70 offen sc1
    s_add_u32 s84, s84, 8
    s_waitcnt vmcnt(0)
    v_cmp_ne_u32 vcc, s6, v7
    s_cmp_gt_u32 s84, 200000
    s_cbranch_scc1 P_78
    s_cbranch_vccnz P_77
P_78:
    s_add_u32 s10, s64, 0
    buffer_load_dwordx4 v[128:131], v2, s[76:79], s10 offen offset:0 sc1
    buffer_load_dwordx4 v[132:135], v2, s[76:79], s10 offen offset:1024 sc1
    buffer_load_dwordx4 v[136:139], v2, s[76:79], s10 offen offset:2048 sc1
    buffer_load_dwordx4 v[140:143], v2, s[76:79], s10 offen offset:3072 sc1
    s_add_u32 s10, s64, 4096
    buffer_load_dwordx4 v[144:147], v2, s[76:79], s10 offen offset:0 sc1
    buffer_load_dwordx4 v[148:151], v2, s[76:79], s10 offen offset:1024 sc1
    buffer_load_dwordx4 v[152:155], v2, s[76:79], s10 offen offset:2048 sc1
    buffer_load_dwordx4 v[156:159], v2, s[76:79], s10 offen offset:3072 sc1
    s_waitcnt vmcnt(7) lgkmcnt(15)
    v_mfma_f32_32x32x16_bf16 v[60:75], v[196:199], v[128:131], 0
    v_mfma_f32_32x32x16_bf16 v[44:59], v[192:195], v[128:131], 0
    s_add_u32 s10, s64, 8192
    buffer_load_dwordx4 v[160:163], v2, s[76:79], s10 offen offset:0 sc1
    buffer_load_dwordx4 v[164:167], v2, s[76:79], s10 offen offset:1024 sc1
    s_waitcnt vmcnt(8)
    v_mfma_f32_32x32x16_bf16 v[60:75], v[204:207], v[132:135], v[60:75]
    v_mfma_f32_32x32x16_bf16 v[44:59], v[200:203], v[132:135], v[44:59]
    s_add_u32 s10, s65, 10240
    buffer_load_dwordx4 v[168:171], v2, s[76:79], s10 offen offset:0 sc1
    s_waitcnt vmcnt(8)
    v_mfma_f32_32x32x16_bf16 v[60:75], v[212:215], v[136:139], v[60:75]
    v_mfma_f32_32x32x16_bf16 v[44:59], v[208:211], v[136:139], v[44:59]
    buffer_load_dwordx4 v[172:175], v2, s[76:79], s10 offen offset:1024 sc1
    s_waitcnt vmcnt(8)
    v_mfma_f32_32x32x16_bf16 v[60:75], v[220:223], v[140:143], v[60:75]
    v_mfma_f32_32x32x16_bf16 v[44:59], v[216:219], v[140:143], v[44:59]
    buffer_load_dwordx4 v[176:179], v2, s[76:79], s10 offen offset:2048 sc1
    s_waitcnt vmcnt(8)
    v_mfma_f32_32x32x16_bf16 v[60:75], v[228:231], v[144:147], v[60:75]
    v_mfma_f32_32x32x16_bf16 v[44:59], v[224:227], v[144:147], v[44:59]
    buffer_load_dwordx4 v[180:183], v2, s[76:79], s10 offen offset:3072 sc1
    s_add_u32 s10, s65, 14336
    buffer_load_dwordx4 v[184:187], v2, s[76:79], s10 offen offset:0 sc1
    s_waitcnt vmcnt(9)
    v_mfma_f32_32x32x16_bf16 v[60:75], v[236:239], v[148:151], v[60:75]
    v_mfma_f32_32x32x16_bf16 v[44:59], v[232:235], v[148:151], v[44:59]
    buffer_load_dwordx4 v[188:191], v2, s[76:79], s10 offen offset:1024 sc1
    s_waitcnt vmcnt(9)
    v_mfma_f32_32x32x16_bf16 v[60:75], v[244:247], v[152:155], v[60:75]
    v_mfma_f32_32x32x16_bf16 v[44:59], v[240:243], v[152:155], v[44:59]
    ds_read_b32 v6, v4 offset:84
    buffer_load_dwordx4 v[76:79], v2, s[76:79], s10 offen offset:2048 sc1
    s_waitcnt vmcnt(9) lgkmcnt(14)
    v_mfma_f32_32x32x16_bf16 v[60:75], v[252:255], v[156:159], v[60:75]
    v_mfma_f32_32x32x16_bf16 v[44:59], v[248:251], v[156:159], v[44:59]
    buffer_load_dwordx4 v[80:83], v2, s[76:79], s10 offen offset:3072 sc1
    s_waitcnt vmcnt(9) lgkmcnt(9)
    v_mfma_f32_32x32x16_bf16 v[60:75], v[12:15], v[160:163], v[60:75]
    v_mfma_f32_32x32x16_bf16 v[44:59], v[8:11], v[160:163], v[44:59]
    s_waitcnt lgkmcnt(0)
    v_cmp_eq_u32 vcc, s96, v6
    s_cbranch_vccnz F_80
F_79:
    ds_read_b32 v6, v4 offset:84
    s_add_u32 s84, s84, 1
    s_waitcnt lgkmcnt(0)
    v_cmp_ne_u32 vcc, s96, v6
    s_cmp_gt_u32 s84, 200000
    s_cbranch_scc1 F_80
    s_cbranch_vccnz F_79
F_80:
    ds_read_b64_tr_b16 v[8:9], v116 offset:0
    ds_read_b64_tr_b16 v[10:11], v116 offset:512
    ds_read_b64_tr_b16 v[12:13], v117 offset:0
    ds_read_b64_tr_b16 v[14:15], v117 offset:512
    s_add_u32 s10, s65, 18432
    buffer_load_dwordx4 v[84:87], v2, s[76:79], s10 offen offset:0 sc1
    buffer_load_dwordx4 v[88:91], v2, s[76:79], s10 offen offset:1024 sc1
    s_waitcnt vmcnt(10)
    v_mfma_f32_32x32x16_bf16 v[60:75], v[20:23], v[164:167], v[60:75]
    v_mfma_f32_32x32x16_bf16 v[44:59], v[16:19], v[164:167], v[44:59]
    ds_read_b64_tr_b16 v[16:17], v116 offset:2048
    ds_read_b64_tr_b16 v[18:19], v116 offset:2560
    ds_read_b64_tr_b16 v[20:21], v117 offset:2048
    ds_read_b64_tr_b16 v[22:23], v117 offset:2560
    buffer_load_dwordx4 v[92:95], v2, s[76:79], s10 offen offset:2048 sc1
    s_waitcnt vmcnt(10)
    v_mfma_f32_32x32x16_bf16 v[60:75], v[28:31], v[168:171], v[60:75]
    v_mfma_f32_32x32x16_bf16 v[44:59], v[24:27], v[168:171], v[44:59]
    ds_read_b64_tr_b16 v[24:25], v116 offset:4096
    ds_read_b64_tr_b16 v[26:27], v116 offset:4608
    ds_read_b64_tr_b16 v[28:29], v117 offset:4096
    ds_read_b64_tr_b16 v[30:31], v117 offset:4608
    s_add_u32 s10, s66, 21504
    buffer_load_dwordx4 v[96:99], v2, s[76:79], s10 offen offset:0 sc1
    s_waitcnt vmcnt(10) lgkmcnt(8)
    v_mfma_f32_32x32x16_bf16 v[60:75], v[12:15], v[172:175], v[60:75]
    v_mfma_f32_32x32x16_bf16 v[44:59], v[8:11], v[172:175], v[44:59]
    ds_read_b64_tr_b16 v[8:9], v116 offset:6144
    ds_read_b64_tr_b16 v[10:11], v116 offset:6656
    ds_read_b64_tr_b16 v[12:13], v117 offset:6144
    ds_read_b64_tr_b16 v[14:15], v117 offset:6656
    buffer_load_dwordx4 v[100:103], v2, s[76:79], s10 offen offset:1024 sc1
    s_waitcnt vmcnt(10) lgkmcnt(8)
    v_mfma_f32_32x32x16_bf16 v[60:75], v[20:23], v[176:179], v[60:75]
    v_mfma_f32_32x32x16_bf16 v[44:59], v[16:19], v[176:179], v[44:59]
    ds_read_b64_tr_b16 v[16:17], v116 offset:8192
    ds_read_b64_tr_b16 v[18:19], v116 offset:8704
    ds_read_b64_tr_b16 v[20:21], v117 offset:8192
    ds_read_b64_tr_b16 v[22:23], v117 offset:8704
    buffer_load_dwordx4 v[112:115], v2, s[76:79], s10 offen offset:2048 sc1
    buffer_load_dwordx4 v[120:123], v2, s[76:79], s10 offen offset:3072 sc1
    s_waitcnt vmcnt(11) lgkmcnt(8)
    v_mfma_f32_32x32x16_bf16 v[60:75], v[28:31], v[180:183], v[60:75]
    v_mfma_f32_32x32x16_bf16 v[44:59], v[24:27], v[180:183], v[44:59]
    ds_read_b64_tr_b16 v[24:25], v116 offset:10240
    ds_read_b64_tr_b16 v[26:27], v116 offset:10752
    ds_read_b64_tr_b16 v[28:29], v117 offset:10240
    ds_read_b64_tr_b16 v[30:31], v117 offset:10752
    s_add_u32 s10, s66, 25600
    buffer_load_dwordx4 v[124:127], v2, s[76:79], s10 offen offset:0 sc1
    s_waitcnt vmcnt(11) lgkmcnt(8)
    v_mfma_f32_32x32x16_bf16 v[60:75], v[12:15], v[184:187], v[60:75]
    v_mfma_f32_32x32x16_bf16 v[44:59], v[8:11], v[184:187], v[44:59]
    ds_read_b64_tr_b16 v[8:9], v116 offset:12288
    ds_read_b64_tr_b16 v[10:11], v116 offset:12800
    ds_read_b64_tr_b16 v[12:13], v117 offset:12288
    ds_read_b64_tr_b16 v[14:15], v117 offset:12800
    buffer_load_dwordx4 v[128:131], v2, s[76:79], s10 offen offset:1024 sc1
    s_waitcnt vmcnt(11) lgkmcnt(8)
    v_mfma_f32_32x32x16_bf16 v[60:75], v[20:23], v[188:191], v[60:75]
    v_mfma_f32_32x32x16_bf16 v[44:59], v[16:19], v[188:191], v[44:59]
    ds_read_b64_tr_b16 v[16:17], v116 offset:14336
    ds_read_b64_tr_b16 v[18:19], v116 offset:14848
    ds_read_b64_tr_b16 v[20:21], v117 offset:14336
    ds_read_b64_tr_b16 v[22:23], v117 offset:14848
    buffer_load_dwordx4 v[132:135], v2, s[76:79], s10 offen offset:2048 sc1
    s_waitcnt vmcnt(11) lgkmcnt(8)
    v_mfma_f32_32x32x16_bf16 v[60:75], v[28:31], v[76:79], v[60:75]
    v_mfma_f32_32x32x16_bf16 v[44:59], v[24:27], v[76:79], v[44:59]
    ds_read_b64_tr_b16 v[24:25], v116 offset:16384
    ds_read_b64_tr_b16 v[26:27], v116 offset:16896
    ds_read_b64_tr_b16 v[28:29], v117 offset:16384
    ds_read_b64_tr_b16 v[30:31], v117 offset:16896
    buffer_load_dwordx4 v[136:139], v2, s[76:79], s10 offen offset:3072 sc1
    s_add_u32 s10, s66, 29696
    buffer_load_dwordx4 v[140:143], v2, s[76:79], s10 offen offset:0 sc1
    s_waitcnt vmcnt(12) lgkmcnt(8)
    v_mfma_f32_32x32x16_bf16 v[60:75], v[12:15], v[80:83], v[60:75]
    v_mfma_f32_32x32x16_bf16 v[44:59], v[8:11], v[80:83], v[44:59]
    ds_read_b32 v6, v4 offset:88
    ds_read_b64_tr_b16 v[8:9], v116 offset:18432
    ds_read_b64_tr_b16 v[10:11], v116 offset:18944
    ds_read_b64_tr_b16 v[12:13], v117 offset:18432
    ds_read_b64_tr_b16 v[14:15], v117 offset:18944
    buffer_load_dwordx4 v[144:147], v2, s[76:79], s10 offen offset:1024 sc1
    s_waitcnt vmcnt(12) lgkmcnt(9)
    v_mfma_f32_32x32x16_bf16 v[60:75], v[20:23], v[84:87], v[60:75]
    v_mfma_f32_32x32x16_bf16 v[44:59], v[16:19], v[84:87], v[44:59]
    ds_read_b64_tr_b16 v[16:17], v116 offset:20480
    ds_read_b64_tr_b16 v[18:19], v116 offset:20992
    ds_read_b64_tr_b16 v[20:21], v117 offset:20480
    ds_read_b64_tr_b16 v[22:23], v117 offset:20992
    buffer_load_dwordx4 v[148:151], v2, s[76:79], s10 offen offset:2048 sc1
    s_waitcnt vmcnt(12) lgkmcnt(9)
    v_mfma_f32_32x32x16_bf16 v[60:75], v[28:31], v[88:91], v[60:75]
    v_mfma_f32_32x32x16_bf16 v[44:59], v[24:27], v[88:91], v[44:59]
    ds_read_b64_tr_b16 v[24:25], v116 offset:22528
    ds_read_b64_tr_b16 v[26:27], v116 offset:23040
    ds_read_b64_tr_b16 v[28:29], v117 offset:22528
    ds_read_b64_tr_b16 v[30:31], v117 offset:23040
    s_add_u32 s10, s67, 32768
    buffer_load_dwordx4 v[152:155], v2, s[76:79], s10 offen offset:0 sc1
    s_waitcnt vmcnt(12) lgkmcnt(8)
    v_mfma_f32_32x32x16_bf16 v[60:75], v[12:15], v[92:95], v[60:75]
    v_mfma_f32_32x32x16_bf16 v[44:59], v[8:11], v[92:95], v[44:59]
    v_cmp_eq_u32 vcc, s96, v6
    s_cbranch_vccnz F_82
F_81:
    ds_read_b32 v6, v4 offset:88
    s_add_u32 s84, s84, 1
    s_waitcnt lgkmcnt(0)
    v_cmp_ne_u32 vcc, s96, v6
    s_cmp_gt_u32 s84, 200000
    s_cbranch_scc1 F_82
    s_cbranch_vccnz F_81
F_82:
    ds_read_b64_tr_b16 v[8:9], v116 offset:24576
    ds_read_b64_tr_b16 v[10:11], v116 offset:25088
    ds_read_b64_tr_b16 v[12:13], v117 offset:24576
    ds_read_b64_tr_b16 v[14:15], v117 offset:25088
    buffer_load_dwordx4 v[240:243], v2, s[76:79], s10 offen offset:1024 sc1
    buffer_load_dwordx4 v[244:247], v2, s[76:79], s10 offen offset:2048 sc1
    s_waitcnt vmcnt(13) lgkmcnt(8)
    v_mfma_f32_32x32x16_bf16 v[60:75], v[20:23], v[96:99], v[60:75]
    v_mfma_f32_32x32x16_bf16 v[44:59], v[16:19], v[96:99], v[44:59]
    ds_read_b64_tr_b16 v[16:17], v116 offset:26624
    ds_read_b64_tr_b16 v[18:19], v116 offset:27136
    ds_read_b64_tr_b16 v[20:21], v117 offset:26624
    ds_read_b64_tr_b16 v[22:23], v117 offset:27136
    buffer_load_dwordx4 v[156:159], v2, s[76:79], s10 offen offset:3072 sc1
    s_waitcnt vmcnt(13) lgkmcnt(8)
    v_mfma_f32_32x32x16_bf16 v[60:75], v[28:31], v[100:103], v[60:75]
    v_mfma_f32_32x32x16_bf16 v[44:59], v[24:27], v[100:103], v[44:59]
    ds_read_b64_tr_b16 v[24:25], v116 offset:28672
    ds_read_b64_tr_b16 v[26:27], v116 offset:29184
    ds_read_b64_tr_b16 v[28:29], v117 offset:28672
    ds_read_b64_tr_b16 v[30:31], v117 offset:29184
    s_add_u32 s10, s67, 36864
    buffer_load_dwordx4 v[248:251], v2, s[76:79], s10 offen offset:0 sc1
    s_waitcnt vmcnt(13) lgkmcnt(8)
    v_mfma_f32_32x32x16_bf16 v[60:75], v[12:15], v[112:115], v[60:75]
    v_mfma_f32_32x32x16_bf16 v[44:59], v[8:11], v[112:115], v[44:59]
    ds_read_b64_tr_b16 v[8:9], v116 offset:30720
    ds_read_b64_tr_b16 v[10:11], v116 offset:31232
    ds_read_b64_tr_b16 v[12:13], v117 offset:30720
    ds_read_b64_tr_b16 v[14:15], v117 offset:31232
    buffer_load_dwordx4 v[252:255], v2, s[76:79], s10 offen offset:1024 sc1
    s_waitcnt vmcnt(13) lgkmcnt(8)
    v_mfma_f32_32x32x16_bf16 v[60:75], v[20:23], v[120:123], v[60:75]
    v_mfma_f32_32x32x16_bf16 v[44:59], v[16:19], v[120:123], v[44:59]
    ds_read_b64_tr_b16 v[16:17], v116 offset:32768
    ds_read_b64_tr_b16 v[18:19], v116 offset:33280
    ds_read_b64_tr_b16 v[20:21], v117 offset:32768
    ds_read_b64_tr_b16 v[22:23], v117 offset:33280
    buffer_load_dwordx4 v[160:163], v2, s[76:79], s10 offen offset:2048 sc1
    buffer_load_dwordx4 v[164:167], v2, s[76:79], s10 offen offset:3072 sc1
    ds_read_b128 v[192:195], v36 offset:640
    ds_read_b128 v[196:199], v36 offset:656
    ds_read_b128 v[200:203], v36 offset:704
    ds_read_b128 v[204:207], v36 offset:720
    ds_read_b32 v224, v41 offset:128
    s_waitcnt vmcnt(14) lgkmcnt(13)
    v_mfma_f32_32x32x16_bf16 v[60:75], v[28:31], v[124:127], v[60:75]
    v_mfma_f32_32x32x16_bf16 v[44:59], v[24:27], v[124:127], v[44:59]
    ds_read_b64_tr_b16 v[24:25], v116 offset:34816
    ds_read_b64_tr_b16 v[26:27], v116 offset:35328
    ds_read_b64_tr_b16 v[28:29], v117 offset:34816
    ds_read_b64_tr_b16 v[30:31], v117 offset:35328
    s_add_u32 s10, s67, 40960
    buffer_load_dwordx4 v[168:171], v2, s[76:79], s10 offen offset:0 sc1
    s_waitcnt vmcnt(14) lgkmcnt(13)
    v_mfma_f32_32x32x16_bf16 v[60:75], v[12:15], v[128:131], v[60:75]
    v_mfma_f32_32x32x16_bf16 v[44:59], v[8:11], v[128:131], v[44:59]
    ds_read_b64_tr_b16 v[8:9], v116 offset:36864
    ds_read_b64_tr_b16 v[10:11], v116 offset:37376
    ds_read_b64_tr_b16 v[12:13], v117 offset:36864
    ds_read_b64_tr_b16 v[14:15], v117 offset:37376
    buffer_load_dwordx4 v[172:175], v2, s[76:79], s10 offen offset:1024 sc1
    v_lshlrev_b32 v208, 16, v104
    v_and_b32 v209, 0xffff0000, v104
    s_waitcnt lgkmcnt(8)
    v_mul_f32 v192, v224, v192
    v_mul_f32 v193, v224, v193
    s_waitcnt vmcnt(14)
    v_mfma_f32_32x32x16_bf16 v[60:75], v[20:23], v[132:135], v[60:75]
    v_mfma_f32_32x32x16_bf16 v[44:59], v[16:19], v[132:135], v[44:59]
    ds_read_b64_tr_b16 v[16:17], v116 offset:38912
    ds_read_b64_tr_b16 v[18:19], v116 offset:39424
    ds_read_b64_tr_b16 v[20:21], v117 offset:38912
    ds_read_b64_tr_b16 v[22:23], v117 offset:39424
    buffer_load_dwordx4 v[176:179], v2, s[76:79], s10 offen offset:2048 sc1
    v_lshlrev_b32 v210, 16, v105
    v_and_b32 v211, 0xffff0000, v105
    v_mul_f32 v194, v224, v194
    v_mul_f32 v195, v224, v195
    s_waitcnt vmcnt(14) lgkmcnt(8)
    v_mfma_f32_32x32x16_bf16 v[60:75], v[28:31], v[136:139], v[60:75]
    v_mfma_f32_32x32x16_bf16 v[44:59], v[24:27], v[136:139], v[44:59]
    ds_read_b64_tr_b16 v[24:25], v116 offset:40960
    ds_read_b64_tr_b16 v[26:27], v116 offset:41472
    ds_read_b64_tr_b16 v[28:29], v117 offset:40960
    ds_read_b64_tr_b16 v[30:31], v117 offset:41472
    v_lshlrev_b32 v212, 16, v106
    v_and_b32 v213, 0xffff0000, v106
    v_mul_f32 v196, v224, v196
    v_mul_f32 v197, v224, v197
    s_waitcnt vmcnt(13) lgkmcnt(8)
    v_mfma_f32_32x32x16_bf16 v[60:75], v[12:15], v[140:143], v[60:75]
    v_mfma_f32_32x32x16_bf16 v[44:59], v[8:11], v[140:143], v[44:59]
    ds_read_b32 v6, v4 offset:92
    ds_read_b64_tr_b16 v[8:9], v116 offset:43008
    ds_read_b64_tr_b16 v[10:11], v116 offset:43520
    ds_read_b64_tr_b16 v[12:13], v117 offset:43008
    ds_read_b64_tr_b16 v[14:15], v117 offset:43520
    v_lshlrev_b32 v214, 16, v107
    v_and_b32 v215, 0xffff0000, v107
    v_mul_f32 v198, v224, v198
    v_mul_f32 v199, v224, v199
    s_waitcnt vmcnt(12) lgkmcnt(9)
    v_mfma_f32_32x32x16_bf16 v[60:75], v[20:23], v[144:147], v[60:75]
    v_mfma_f32_32x32x16_bf16 v[44:59], v[16:19], v[144:147], v[44:59]
    ds_read_b64_tr_b16 v[16:17], v116 offset:45056
    ds_read_b64_tr_b16 v[18:19], v116 offset:45568
    ds_read_b64_tr_b16 v[20:21], v117 offset:45056
    ds_read_b64_tr_b16 v[22:23], v117 offset:45568
    v_lshlrev_b32 v216, 16, v108
    v_and_b32 v217, 0xffff0000, v108
    v_mul_f32 v200, v224, v200
    v_mul_f32 v201, v224, v201
    s_waitcnt vmcnt(11) lgkmcnt(9)
    v_mfma_f32_32x32x16_bf16 v[60:75], v[28:31], v[148:151], v[60:75]
    v_mfma_f32_32x32x16_bf16 v[44:59], v[24:27], v[148:151], v[44:59]
    ds_read_b64_tr_b16 v[24:25], v116 offset:47104
    ds_read_b64_tr_b16 v[26:27], v116 offset:47616
    ds_read_b64_tr_b16 v[28:29], v117 offset:47104
    ds_read_b64_tr_b16 v[30:31], v117 offset:47616
    v_lshlrev_b32 v218, 16, v109
    v_and_b32 v219, 0xffff0000, v109
    v_mul_f32 v202, v224, v202
    v_mul_f32 v203, v224, v203
    s_waitcnt vmcnt(10) lgkmcnt(8)
    v_mfma_f32_32x32x16_bf16 v[60:75], v[12:15], v[152:155], v[60:75]
    v_mfma_f32_32x32x16_bf16 v[44:59], v[8:11], v[152:155], v[44:59]
    v_cmp_eq_u32 vcc, s96, v6
    s_cbranch_vccnz F_84
F_83:
    ds_read_b32 v6, v4 offset:92
    s_add_u32 s84, s84, 1
    s_waitcnt lgkmcnt(0)
    v_cmp_ne_u32 vcc, s96, v6
    s_cmp_gt_u32 s84, 200000
    s_cbranch_scc1 F_84
    s_cbranch_vccnz F_83
F_84:
    ds_read_b64_tr_b16 v[8:9], v33 offset:0
    ds_read_b64_tr_b16 v[10:11], v33 offset:512
    ds_read_b64_tr_b16 v[12:13], v37 offset:0
    ds_read_b64_tr_b16 v[14:15], v37 offset:512
    v_lshlrev_b32 v220, 16, v110
    v_and_b32 v221, 0xffff0000, v110
    v_mul_f32 v204, v224, v204
    v_mul_f32 v205, v224, v205
    s_waitcnt vmcnt(9) lgkmcnt(8)
    v_mfma_f32_32x32x16_bf16 v[60:75], v[20:23], v[240:243], v[60:75]
    v_mfma_f32_32x32x16_bf16 v[44:59], v[16:19], v[240:243], v[44:59]
    ds_read_b64_tr_b16 v[16:17], v33 offset:2048
    ds_read_b64_tr_b16 v[18:19], v33 offset:2560
    ds_read_b64_tr_b16 v[20:21], v37 offset:2048
    ds_read_b64_tr_b16 v[22:23], v37 offset:2560
    v_lshlrev_b32 v222, 16, v111
    v_and_b32 v223, 0xffff0000, v111
    v_mul_f32 v206, v224, v206
    v_mul_f32 v207, v224, v207
    s_waitcnt vmcnt(8) lgkmcnt(8)
    v_mfma_f32_32x32x16_bf16 v[60:75], v[28:31], v[244:247], v[60:75]
    v_mfma_f32_32x32x16_bf16 v[44:59], v[24:27], v[244:247], v[44:59]
    ds_read_b64_tr_b16 v[24:25], v33 offset:4096
    ds_read_b64_tr_b16 v[26:27], v33 offset:4608
    ds_read_b64_tr_b16 v[28:29], v37 offset:4096
    ds_read_b64_tr_b16 v[30:31], v37 offset:4608
    s_waitcnt vmcnt(7) lgkmcnt(8)
    v_mfma_f32_32x32x16_bf16 v[60:75], v[12:15], v[156:159], v[60:75]
    v_mfma_f32_32x32x16_bf16 v[44:59], v[8:11], v[156:159], v[44:59]
    ds_read_b64_tr_b16 v[8:9], v33 offset:6144
    ds_read_b64_tr_b16 v[10:11], v33 offset:6656
    ds_read_b64_tr_b16 v[12:13], v37 offset:6144
    ds_read_b64_tr_b16 v[14:15], v37 offset:6656
    s_waitcnt vmcnt(6) lgkmcnt(8)
    v_mfma_f32_32x32x16_bf16 v[60:75], v[20:23], v[248:251], v[60:75]
    v_mfma_f32_32x32x16_bf16 v[44:59], v[16:19], v[248:251], v[44:59]
    ds_read_b64_tr_b16 v[16:17], v33 offset:8192
    ds_read_b64_tr_b16 v[18:19], v33 offset:8704
    ds_read_b64_tr_b16 v[20:21], v37 offset:8192
    ds_read_b64_tr_b16 v[22:23], v37 offset:8704
    s_waitcnt vmcnt(5) lgkmcnt(8)
    v_mfma_f32_32x32x16_bf16 v[60:75], v[28:31], v[252:255], v[60:75]
    v_mfma_f32_32x32x16_bf16 v[44:59], v[24:27], v[252:255], v[44:59]
    ds_read_b64_tr_b16 v[24:25], v33 offset:10240
    ds_read_b64_tr_b16 v[26:27], v33 offset:10752
    ds_read_b64_tr_b16 v[28:29], v37 offset:10240
    ds_read_b64_tr_b16 v[30:31], v37 offset:10752
    s_waitcnt vmcnt(4) lgkmcnt(8)
    v_mfma_f32_32x32x16_bf16 v[60:75], v[12:15], v[160:163], v[60:75]
    v_mfma_f32_32x32x16_bf16 v[44:59], v[8:11], v[160:163], v[44:59]
    ds_read_b64_tr_b16 v[8:9], v33 offset:12288
    ds_read_b64_tr_b16 v[10:11], v33 offset:12800
    ds_read_b64_tr_b16 v[12:13], v37 offset:12288
    ds_read_b64_tr_b16 v[14:15], v37 offset:12800
    s_waitcnt vmcnt(3) lgkmcnt(8)
    v_mfma_f32_32x32x16_bf16 v[60:75], v[20:23], v[164:167], v[60:75]
    v_mfma_f32_32x32x16_bf16 v[44:59], v[16:19], v[164:167], v[44:59]
    ds_read_b64_tr_b16 v[16:17], v33 offset:14336
    ds_read_b64_tr_b16 v[18:19], v33 offset:14848
    ds_read_b64_tr_b16 v[20:21], v37 offset:14336
    ds_read_b64_tr_b16 v[22:23], v37 offset:14848
    s_waitcnt vmcnt(2) lgkmcnt(8)
    v_mfma_f32_32x32x16_bf16 v[60:75], v[28:31], v[168:171], v[60:75]
    v_mfma_f32_32x32x16_bf16 v[44:59], v[24:27], v[168:171], v[44:59]
    s_waitcnt vmcnt(1) lgkmcnt(4)
    v_mfma_f32_32x32x16_bf16 v[60:75], v[12:15], v[172:175], v[60:75]
    v_mfma_f32_32x32x16_bf16 v[44:59], v[8:11], v[172:175], v[44:59]
    s_waitcnt vmcnt(0) lgkmcnt(0)
    v_mfma_f32_32x32x16_bf16 v[60:75], v[20:23], v[176:179], v[60:75]
    v_mfma_f32_32x32x16_bf16 v[44:59], v[16:19], v[176:179], v[44:59]
    s_nop 10
    ds_write_b128 v34, v[60:63] offset:0
    ds_write_b128 v34, v[64:67] offset:1024
    ds_write_b128 v34, v[68:71] offset:2048
    ds_write_b128 v34, v[72:75] offset:3072
    s_mov_b64 exec, 1
    ds_write_b8 v0, v5 offset:96
    s_mov_b64 exec, -1
    v_fma_f32 v208, v192, v44, v208
    v_fma_f32 v209, v193, v45, v209
    v_fma_f32 v210, v194, v46, v210
    v_fma_f32 v211, v195, v47, v211
    ds_read_u8 v6, v39 offset:96
    v_fma_f32 v212, v196, v48, v212
    v_fma_f32 v213, v197, v49, v213
    v_fma_f32 v214, v198, v50, v214
    v_fma_f32 v215, v199, v51, v215
    v_fma_f32 v216, v200, v52, v216
    v_fma_f32 v217, v201, v53, v217
    v_fma_f32 v218, v202, v54, v218
    v_fma_f32 v219, v203, v55, v219
    v_fma_f32 v220, v204, v56, v220
    v_fma_f32 v221, v205, v57, v221
    v_fma_f32 v222, v206, v58, v222
    v_fma_f32 v223, v207, v59, v223
    s_waitcnt lgkmcnt(0)
    v_cmp_eq_u32 vcc, 1, v6
    s_cbranch_vccnz F_86
F_85:
    ds_read_u8 v6, v39 offset:96
    s_add_u32 s84, s84, 1
    s_waitcnt lgkmcnt(0)
    v_cmp_ne_u32 vcc, 1, v6
    s_cmp_gt_u32 s84, 200000
    s_cbranch_scc1 F_86
    s_cbranch_vccnz F_85
F_86:
    ds_read_b128 v[224:227], v35 offset:0
    ds_read_b128 v[228:231], v35 offset:1024
    ds_read_b128 v[232:235], v35 offset:2048
    ds_read_b128 v[236:239], v35 offset:3072
    s_waitcnt lgkmcnt(3)
    v_fma_f32 v208, v192, v224, v208
    v_fma_f32 v209, v193, v225, v209
    v_cvt_pk_bf16_f32 v104, v208, v209
    v_fma_f32 v210, v194, v226, v210
    v_fma_f32 v211, v195, v227, v211
    v_cvt_pk_bf16_f32 v105, v210, v211
    s_waitcnt lgkmcnt(2)
    v_fma_f32 v212, v196, v228, v212
    v_fma_f32 v213, v197, v229, v213
    v_cvt_pk_bf16_f32 v106, v212, v213
    v_fma_f32 v214, v198, v230, v214
    v_fma_f32 v215, v199, v231, v215
    v_cvt_pk_bf16_f32 v107, v214, v215
    buffer_store_dwordx4 v[104:107], v40, s[72:75], 0 offen offset:0
    s_waitcnt lgkmcnt(1)
    v_fma_f32 v216, v200, v232, v216
    v_fma_f32 v217, v201, v233, v217
    v_cvt_pk_bf16_f32 v108, v216, v217
    v_fma_f32 v218, v202, v234, v218
    v_fma_f32 v219, v203, v235, v219
    v_cvt_pk_bf16_f32 v109, v218, v219
    s_waitcnt lgkmcnt(0)
    v_fma_f32 v220, v204, v236, v220
    v_fma_f32 v221, v205, v237, v221
    v_cvt_pk_bf16_f32 v110, v220, v221
    v_fma_f32 v222, v206, v238, v222
    v_fma_f32 v223, v207, v239, v223
    v_cvt_pk_bf16_f32 v111, v222, v223
    buffer_store_dwordx4 v[108:111], v40, s[72:75], 0 offen offset:32
    s_or_b32 s10, s2, s5
    s_cbranch_scc1 L_87
    s_mov_b64 exec, 1
    buffer_store_dword v38, off, s[76:79], 0 sc1
    s_mov_b64 exec, -1
L_87:
    s_endpgm
A_32:
    buffer_store_dwordx4 v[8:11], v2, s[76:79], s85 offen offset:0 sc1
    s_nop 1
    s_branch B_33
A_34:
    buffer_store_dwordx4 v[12:15], v2, s[76:79], s85 offen offset:1024 sc1
    s_nop 1
    s_branch B_35
A_36:
    buffer_store_dword v38, off, s[76:79], s69 sc1
    s_nop 1
    s_branch B_37
A_48:
    buffer_store_dwordx4 v[8:11], v2, s[72:75], s85 offen offset:0 sc1
    s_nop 1
    s_branch B_49
A_50:
    buffer_store_dwordx4 v[12:15], v2, s[72:75], s85 offen offset:1024 sc1
    s_nop 1
    s_branch B_51
A_52:
    buffer_store_dwordx2 v[16:17], v41, s[76:79], s86 offen sc1
    s_nop 1
    s_branch B_53
A_54:
    buffer_store_dword v38, off, s[76:79], s71 sc1
    s_nop 1
    s_branch B_55
A_64:
    buffer_store_dwordx4 v[128:131], v2, s[76:79], s99 offen offset:0 sc1
    buffer_store_dwordx4 v[132:135], v2, s[76:79], s99 offen offset:1024 sc1
    s_nop 1
    s_branch B_65
A_66:
    buffer_store_dwordx4 v[136:139], v2, s[76:79], s99 offen offset:2048 sc1
    buffer_store_dwordx4 v[140:143], v2, s[76:79], s99 offen offset:3072 sc1
    s_nop 1
    s_branch B_67
A_68:
    buffer_store_dwordx4 v[144:147], v2, s[76:79], s99 offen offset:0 sc1
    s_nop 1
    s_branch B_69
A_71:
    buffer_store_dwordx4 v[148:151], v2, s[76:79], s99 offen offset:1024 sc1
    s_nop 1
    s_branch B_72
A_75:
    buffer_store_dword v38, off, s[76:79], s69 sc1
    s_nop 1
    s_branch B_76
L_end:
    s_endpgm
.section .rodata,"a"
.p2align 6
.amdhsa_kernel adaLN_cond__linear_kernel_hedgehog__dense_activation_relu__prompt_kernel
  .amdhsa_next_free_vgpr 256
  .amdhsa_next_free_sgpr 102
  .amdhsa_accum_offset 256
  .amdhsa_group_segment_fixed_size 0
  .amdhsa_kernarg_size 96
  .amdhsa_user_sgpr_count 2
  .amdhsa_user_sgpr_kernarg_segment_ptr 1
  .amdhsa_system_sgpr_workgroup_id_x 1
.end_amdhsa_kernel
```
